```python
import torch

def _softmax(x, axis=-1):
    return torch.softmax(x, dim=axis)
def _gelu(x):
    return torch.nn.functional.gelu(x, approximate="tanh")
def _silu(x):
    return torch.nn.functional.silu(x)
def _sigmoid(x):
    return torch.sigmoid(x)
def _layernorm(x, axis=-1, eps=1e-5):
    m = x.mean(dim=axis, keepdim=True)
    v = x.var(dim=axis, keepdim=True, unbiased=False)
    return (x - m) / torch.sqrt(v + eps)
def _scatter_add(tgt, idx, src, axis=0):
    return tgt.clone().index_add_(axis, idx, src)
def _segment_sum(src, seg, n):
    out = torch.zeros((n,) + src.shape[1:], dtype=src.dtype)
    return out.index_add_(0, seg, src)
def _pad(x, pw):
    flat = tuple(v for pair in reversed(pw) for v in pair)
    return torch.nn.functional.pad(x, flat)

kernel_name = 'standalone__gqa_block_cached__near_ridge'

def setup_inputs():

    _w = (lambda a: (lambda t: t.to(torch.bfloat16) if t.is_floating_point() else t)(torch.as_tensor(a)))
    B, Sq, D = 8, 128, 576
    Hq, Hkv, Sk, Dh = 32, 16, 512, 128
    assert Hq % Hkv == 0, (Hq, Hkv)
    return {
        "x": _w((lambda *s: torch.randn(*s, dtype=torch.bfloat16) * 0.8)(B, Sq, D)),
        "k_cache": _w((lambda *s: torch.randn(*s, dtype=torch.bfloat16) * 0.8)(B, Hkv, Sk, Dh)),
        "v_cache": _w((lambda *s: torch.randn(*s, dtype=torch.bfloat16) * 0.05)(B, Hkv, Sk, Dh)),
        "wq": _w((lambda *s: torch.randn(*s, dtype=torch.bfloat16) * 0.8)(D, Hq * Dh) * (D ** -0.5)),
        "wo": _w((lambda *s: torch.randn(*s, dtype=torch.bfloat16) * 0.05)(Hq * Dh, D) * ((Hq * Dh) ** -0.5)),
    }

def reference(x, k_cache, v_cache, wq, wo):
    B, Sq, D = x.shape
    Hq, Dh = 32, 128
    Hkv = k_cache.shape[1]
    rep = Hq // Hkv
    q = (lambda x, *d: x.permute(*d))((x @ wq).reshape(B, Sq, Hq, Dh), 0, 2, 1, 3)
    k = (lambda x, n, axis: torch.repeat_interleave(x, n, dim=axis))(k_cache, rep, axis=1)
    v = (lambda x, n, axis: torch.repeat_interleave(x, n, dim=axis))(v_cache, rep, axis=1)
    scores = torch.einsum("bhqd,bhkd->bhqk", q, k) * (Dh ** -0.5)
    p = _softmax(scores, axis=-1)
    o = torch.einsum("bhqk,bhkd->bhqd", p, v)
    return (lambda x, *d: x.permute(*d))(o, 0, 2, 1, 3).reshape(B, Sq, Hq * Dh) @ wo
```

```asm
; @launch grid=(256,1,1) block=(512,1,1) lds=163840
.amdgcn_target "amdgcn-amd-amdhsa--gfx950"
.text
.globl standalone__gqa_block_cached__near_ridge_kernel
.p2align 12
.p2align 8
.type standalone__gqa_block_cached__near_ridge_kernel,@function
standalone__gqa_block_cached__near_ridge_kernel:
    s_cmp_ge_u32 s2, 256
    s_cbranch_scc1 L_end
    s_load_dwordx16 s[4:19], s[0:1], 0

    v_lshrrev_b32 v1, 6, v0
    v_and_b32 v0, 63, v0
    v_readfirstlane_b32 s20, v1
    s_and_b32 s23, s2, 7
    s_lshr_b32 s3, s2, 3
    s_and_b32 s24, s3, 3
    s_lshr_b32 s21, s3, 2
    s_lshl2_add_u32 s22, s23, s24
    s_and_b32 s25, s20, 3
    s_lshr_b32 s3, s22, 1
    s_lshl4_add_u32 s3, s21, s3
    s_lshl_b32 s26, s3, 17
    s_lshl3_add_u32 s27, s21, s23
    s_lshl_b32 s92, s21, 5

    s_mov_b32 s100, 0
    s_cmp_ge_u32 s20, 4
    s_cbranch_scc1 L_loader
L_pre:
    s_mov_b32 s100, 1
    s_cmp_eq_u32 s20, 0
    s_cbranch_scc1 L_t2
    s_cmp_eq_u32 s20, 1
    s_cbranch_scc1 L_t3
    s_cmp_eq_u32 s20, 2
    s_cbranch_scc1 L_t4
    s_cmp_eq_u32 s20, 3
    s_cbranch_scc1 L_t1
L_wc:
    s_mov_b32 s100, 0
    s_branch L_comp
L_loader:
    v_lshrrev_b32 v1, 3, v0
    s_lshl_b32 s3, s25, 3
    v_add_u32 v1, s3, v1
    v_mul_u32_u24 v1, 1152, v1
    v_lshrrev_b32 v2, 4, v0
    s_and_b32 s3, s25, 1
    s_lshl_b32 s3, s3, 2
    v_add_u32 v3, s3, v2
    v_and_b32 v4, 7, v0
    v_xor_b32 v3, v3, v4
    v_lshl_add_u32 v8, v3, 4, v1
    s_lshl_b32 s3, s25, 2
    v_add_u32 v1, s3, v2
    v_bfe_u32 v3, v0, 2, 2
    v_xor_b32 v3, v3, v2
    v_and_b32 v4, 3, v0
    v_lshlrev_b32 v4, 4, v4
    v_lshl_add_u32 v3, v3, 6, v4
    v_lshl_add_u32 v9, v1, 13, v3
    v_lshl_add_u32 v11, v1, 8, v3
    v_and_b32 v3, 15, v0
    v_xor_b32 v3, v3, v1
    v_lshlrev_b32 v3, 4, v3
    v_lshl_add_u32 v10, v1, 8, v3
    s_lshr_b32 s3, s25, 1
    s_lshl_b32 s3, s3, 5
    v_xor_b32 v9, s3, v9
    s_mul_i32 s60, s21, 147456
    s_lshl_b32 s61, s22, 8
    s_sub_u32 s62, 4718592, s61
    s_lshl_b32 s63, s25, 10

    s_lshl1_add_u32 s68, s24, s21
    s_sub_u32 s3, s68, 7
    s_cselect_b32 s68, s68, s3
    s_mov_b32 s64, 7
    s_waitcnt lgkmcnt(0)
    s_add_u32 s28, s4, s60
    s_addc_u32 s29, s5, 0
    s_mov_b32 s30, 147456
    s_mov_b32 s31, 0x20000
    s_add_u32 s32, s10, s61
    s_addc_u32 s33, s11, 0
    s_mov_b32 s34, s62
    s_mov_b32 s35, 0x20000
    s_lshl_b32 s66, s64, 7
    s_lshl_b32 s67, s64, 19
    s_add_u32 m0, s63, 0
    s_add_u32 s65, s66, 0
    buffer_load_dwordx4 v8, s[28:31], s65 offen  lds
    s_add_u32 m0, s63, 131072
    s_add_u32 s65, s67, 0
    buffer_load_dwordx4 v9, s[32:35], s65 offen  lds
    s_add_u32 m0, s63, 4096
    s_add_u32 s65, s66, 36864
    buffer_load_dwordx4 v8, s[28:31], s65 offen  lds
    s_add_u32 m0, s63, 135168
    s_add_u32 s65, s67, 131072
    buffer_load_dwordx4 v9, s[32:35], s65 offen  lds
    s_add_u32 m0, s63, 8192
    s_add_u32 s65, s66, 73728
    buffer_load_dwordx4 v8, s[28:31], s65 offen  lds
    s_add_u32 m0, s63, 139264
    s_add_u32 s65, s67, 262144
    buffer_load_dwordx4 v9, s[32:35], s65 offen  lds
    s_add_u32 m0, s63, 12288
    s_add_u32 s65, s66, 110592
    buffer_load_dwordx4 v8, s[28:31], s65 offen  lds
    s_add_u32 m0, s63, 143360
    s_add_u32 s65, s67, 393216
    buffer_load_dwordx4 v9, s[32:35], s65 offen  lds
    s_add_u32 s64, s64, 1
    s_lshl_b32 s66, s64, 7
    s_lshl_b32 s67, s64, 19
    s_add_u32 m0, s63, 49152
    s_add_u32 s65, s66, 0
    buffer_load_dwordx4 v8, s[28:31], s65 offen  lds
    s_add_u32 m0, s63, 147456
    s_add_u32 s65, s67, 0
    buffer_load_dwordx4 v9, s[32:35], s65 offen  lds
    s_add_u32 m0, s63, 53248
    s_add_u32 s65, s66, 36864
    buffer_load_dwordx4 v8, s[28:31], s65 offen  lds
    s_add_u32 m0, s63, 151552
    s_add_u32 s65, s67, 131072
    buffer_load_dwordx4 v9, s[32:35], s65 offen  lds
    s_add_u32 m0, s63, 57344
    s_add_u32 s65, s66, 73728
    buffer_load_dwordx4 v8, s[28:31], s65 offen  lds
    s_add_u32 m0, s63, 155648
    s_add_u32 s65, s67, 262144
    buffer_load_dwordx4 v9, s[32:35], s65 offen  lds
    s_add_u32 m0, s63, 61440
    s_add_u32 s65, s66, 110592
    buffer_load_dwordx4 v8, s[28:31], s65 offen  lds
    s_add_u32 m0, s63, 159744
    s_add_u32 s65, s67, 393216
    buffer_load_dwordx4 v9, s[32:35], s65 offen  lds
    s_mov_b32 s64, s68
    s_add_u32 s36, s6, s26
    s_addc_u32 s37, s7, 0
    s_mov_b32 s38, 131072
    s_mov_b32 s39, 0x20000
    s_add_u32 s40, s8, s26
    s_addc_u32 s41, s9, 0
    s_mov_b32 s42, 131072
    s_mov_b32 s43, 0x20000
    s_mov_b32 s48, s18
    s_mov_b32 s49, s19
    s_mov_b32 s50, 67108864
    s_mov_b32 s51, 0x20000
    s_mov_b32 s52, s14
    s_mov_b32 s53, s15
    s_mov_b32 s54, 1179648
    s_mov_b32 s55, 0x20000
    s_mov_b32 s44, s12
    s_mov_b32 s45, s13
    s_mov_b32 s46, 4718592
    s_mov_b32 s47, 0x20000
    s_mov_b32 s56, s16
    s_mov_b32 s57, s17
    s_mov_b32 s58, 256
    s_mov_b32 s59, 0x20000
    s_waitcnt vmcnt(8)
    s_barrier
    s_lshl_b32 s66, s64, 7
    s_lshl_b32 s67, s64, 19
    s_add_u32 m0, s63, 32768
    s_add_u32 s65, s66, 0
    buffer_load_dwordx4 v8, s[28:31], s65 offen  lds
    s_add_u32 m0, s63, 98304
    s_add_u32 s65, s67, 0
    buffer_load_dwordx4 v9, s[32:35], s65 offen  lds
    s_add_u32 m0, s63, 36864
    s_add_u32 s65, s66, 36864
    buffer_load_dwordx4 v8, s[28:31], s65 offen  lds
    s_add_u32 m0, s63, 102400
    s_add_u32 s65, s67, 131072
    buffer_load_dwordx4 v9, s[32:35], s65 offen  lds
    s_add_u32 m0, s63, 40960
    s_add_u32 s65, s66, 73728
    buffer_load_dwordx4 v8, s[28:31], s65 offen  lds
    s_add_u32 m0, s63, 106496
    s_add_u32 s65, s67, 262144
    buffer_load_dwordx4 v9, s[32:35], s65 offen  lds
    s_add_u32 m0, s63, 45056
    s_add_u32 s65, s66, 110592
    buffer_load_dwordx4 v8, s[28:31], s65 offen  lds
    s_add_u32 m0, s63, 110592
    s_add_u32 s65, s67, 393216
    buffer_load_dwordx4 v9, s[32:35], s65 offen  lds
    s_add_u32 s64, s64, 1
    s_cmp_eq_u32 s64, 7
    s_cselect_b32 s64, 0, s64
    s_lshl_b32 s93, s27, 7
    s_add_u32 s93, s93, 35651584
    v_lshlrev_b32 v22, 4, v0
    v_add_u32 v23, 4096, v22
    s_lshl3_add_u32 s3, s23, s21
    s_lshl2_add_u32 s3, s3, s24
    s_lshl2_add_u32 s3, s3, s25
    s_mul_i32 s62, s3, 4608
    s_lshl2_add_u32 s3, s27, s25
    s_lshl_b32 s3, s3, 7
    s_add_u32 s60, s3, 33554432
    s_lshr_b32 s3, s27, 1
    s_lshl2_add_u32 s3, s3, s24
    s_lshl_b32 s3, s3, 10
    s_add_u32 s94, s3, 34603008
    s_lshl_b32 s3, s25, 7
    s_add_u32 s61, s3, s94
    s_lshl2_add_u32 s3, s27, s24
    s_lshl2_add_u32 s3, s3, s25
    s_lshl_b32 s95, s3, 13
    v_lshlrev_b32 v24, 7, v0

    s_waitcnt vmcnt(8)
    s_barrier
    s_lshl_b32 s66, s64, 7
    s_lshl_b32 s67, s64, 19
    s_add_u32 m0, s63, 16384
    s_add_u32 s65, s66, 0
    buffer_load_dwordx4 v8, s[28:31], s65 offen  lds
    s_add_u32 m0, s63, 114688
    s_add_u32 s65, s67, 0
    buffer_load_dwordx4 v9, s[32:35], s65 offen  lds
    s_add_u32 m0, s63, 20480
    s_add_u32 s65, s66, 36864
    buffer_load_dwordx4 v8, s[28:31], s65 offen  lds
    s_add_u32 m0, s63, 118784
    s_add_u32 s65, s67, 131072
    buffer_load_dwordx4 v9, s[32:35], s65 offen  lds
    s_add_u32 m0, s63, 24576
    s_add_u32 s65, s66, 73728
    buffer_load_dwordx4 v8, s[28:31], s65 offen  lds
    s_add_u32 m0, s63, 122880
    s_add_u32 s65, s67, 262144
    buffer_load_dwordx4 v9, s[32:35], s65 offen  lds
    s_add_u32 m0, s63, 28672
    s_add_u32 s65, s66, 110592
    buffer_load_dwordx4 v8, s[28:31], s65 offen  lds
    s_add_u32 m0, s63, 126976
    s_add_u32 s65, s67, 393216
    buffer_load_dwordx4 v9, s[32:35], s65 offen  lds
    s_add_u32 s64, s64, 1
    s_cmp_eq_u32 s64, 7
    s_cselect_b32 s64, 0, s64
    s_waitcnt vmcnt(8)
    s_barrier
    s_lshl_b32 s66, s64, 7
    s_lshl_b32 s67, s64, 19
    s_add_u32 m0, s63, 0
    s_add_u32 s65, s66, 0
    buffer_load_dwordx4 v8, s[28:31], s65 offen  lds
    s_add_u32 m0, s63, 131072
    s_add_u32 s65, s67, 0
    buffer_load_dwordx4 v9, s[32:35], s65 offen  lds
    s_add_u32 m0, s63, 4096
    s_add_u32 s65, s66, 36864
    buffer_load_dwordx4 v8, s[28:31], s65 offen  lds
    s_add_u32 m0, s63, 135168
    s_add_u32 s65, s67, 131072
    buffer_load_dwordx4 v9, s[32:35], s65 offen  lds
    s_add_u32 m0, s63, 8192
    s_add_u32 s65, s66, 73728
    buffer_load_dwordx4 v8, s[28:31], s65 offen  lds
    s_add_u32 m0, s63, 139264
    s_add_u32 s65, s67, 262144
    buffer_load_dwordx4 v9, s[32:35], s65 offen  lds
    s_add_u32 m0, s63, 12288
    s_add_u32 s65, s66, 110592
    buffer_load_dwordx4 v8, s[28:31], s65 offen  lds
    s_add_u32 m0, s63, 143360
    s_add_u32 s65, s67, 393216
    buffer_load_dwordx4 v9, s[32:35], s65 offen  lds
    s_add_u32 s64, s64, 1
    s_cmp_eq_u32 s64, 7
    s_cselect_b32 s64, 0, s64
    s_waitcnt vmcnt(8)
    s_barrier
    s_lshl_b32 s66, s64, 7
    s_lshl_b32 s67, s64, 19
    s_add_u32 m0, s63, 49152
    s_add_u32 s65, s66, 0
    buffer_load_dwordx4 v8, s[28:31], s65 offen  lds
    s_add_u32 m0, s63, 147456
    s_add_u32 s65, s67, 0
    buffer_load_dwordx4 v9, s[32:35], s65 offen  lds
    s_add_u32 m0, s63, 53248
    s_add_u32 s65, s66, 36864
    buffer_load_dwordx4 v8, s[28:31], s65 offen  lds
    s_add_u32 m0, s63, 151552
    s_add_u32 s65, s67, 131072
    buffer_load_dwordx4 v9, s[32:35], s65 offen  lds
    s_add_u32 m0, s63, 57344
    s_add_u32 s65, s66, 73728
    buffer_load_dwordx4 v8, s[28:31], s65 offen  lds
    s_add_u32 m0, s63, 155648
    s_add_u32 s65, s67, 262144
    buffer_load_dwordx4 v9, s[32:35], s65 offen  lds
    s_add_u32 m0, s63, 61440
    s_add_u32 s65, s66, 110592
    buffer_load_dwordx4 v8, s[28:31], s65 offen  lds
    s_add_u32 m0, s63, 159744
    s_add_u32 s65, s67, 393216
    buffer_load_dwordx4 v9, s[32:35], s65 offen  lds
    s_add_u32 s64, s64, 1
    s_cmp_eq_u32 s64, 7
    s_cselect_b32 s64, 0, s64
    s_waitcnt vmcnt(8)
    s_barrier
    s_lshl_b32 s66, s64, 7
    s_lshl_b32 s67, s64, 19
    s_add_u32 m0, s63, 32768
    s_add_u32 s65, s66, 0
    buffer_load_dwordx4 v8, s[28:31], s65 offen  lds
    s_add_u32 m0, s63, 98304
    s_add_u32 s65, s67, 0
    buffer_load_dwordx4 v9, s[32:35], s65 offen  lds
    s_add_u32 m0, s63, 36864
    s_add_u32 s65, s66, 36864
    buffer_load_dwordx4 v8, s[28:31], s65 offen  lds
    s_add_u32 m0, s63, 102400
    s_add_u32 s65, s67, 131072
    buffer_load_dwordx4 v9, s[32:35], s65 offen  lds
    s_add_u32 m0, s63, 40960
    s_add_u32 s65, s66, 73728
    buffer_load_dwordx4 v8, s[28:31], s65 offen  lds
    s_add_u32 m0, s63, 106496
    s_add_u32 s65, s67, 262144
    buffer_load_dwordx4 v9, s[32:35], s65 offen  lds
    s_add_u32 m0, s63, 45056
    s_add_u32 s65, s66, 110592
    buffer_load_dwordx4 v8, s[28:31], s65 offen  lds
    s_add_u32 m0, s63, 110592
    s_add_u32 s65, s67, 393216
    buffer_load_dwordx4 v9, s[32:35], s65 offen  lds
    s_add_u32 s64, s64, 1
    s_cmp_eq_u32 s64, 7
    s_cselect_b32 s64, 0, s64
    s_waitcnt vmcnt(8)
    s_barrier
    s_load_dwordx2 s[96:97], s[16:17], s92
    s_lshl_b32 s66, s64, 7
    s_lshl_b32 s67, s64, 19
    s_add_u32 m0, s63, 16384
    s_add_u32 s65, s66, 0
    buffer_load_dwordx4 v8, s[28:31], s65 offen  lds
    s_add_u32 m0, s63, 114688
    s_add_u32 s65, s67, 0
    buffer_load_dwordx4 v9, s[32:35], s65 offen  lds
    s_add_u32 m0, s63, 20480
    s_add_u32 s65, s66, 36864
    buffer_load_dwordx4 v8, s[28:31], s65 offen  lds
    s_add_u32 m0, s63, 118784
    s_add_u32 s65, s67, 131072
    buffer_load_dwordx4 v9, s[32:35], s65 offen  lds
    s_add_u32 m0, s63, 24576
    s_add_u32 s65, s66, 73728
    buffer_load_dwordx4 v8, s[28:31], s65 offen  lds
    s_add_u32 m0, s63, 122880
    s_add_u32 s65, s67, 262144
    buffer_load_dwordx4 v9, s[32:35], s65 offen  lds
    s_add_u32 m0, s63, 28672
    s_add_u32 s65, s66, 110592
    buffer_load_dwordx4 v8, s[28:31], s65 offen  lds
    s_add_u32 m0, s63, 126976
    s_add_u32 s65, s67, 393216
    buffer_load_dwordx4 v9, s[32:35], s65 offen  lds
    s_add_u32 s64, s64, 1
    s_cmp_eq_u32 s64, 7
    s_cselect_b32 s64, 0, s64
    s_waitcnt lgkmcnt(0)
    s_cmp_eq_u32 s96, 0
    s_cbranch_scc1 L_nonzl
L_nonl:
    v_mov_b32 v252, s96
    v_mov_b32 v253, s97
    s_waitcnt vmcnt(8)
    s_barrier
    s_lshl_b32 s66, s64, 7
    s_lshl_b32 s67, s64, 19
    s_add_u32 m0, s63, 0
    s_add_u32 s65, s66, 0
    buffer_load_dwordx4 v8, s[28:31], s65 offen  lds
    s_add_u32 m0, s63, 131072
    s_add_u32 s65, s67, 0
    buffer_load_dwordx4 v9, s[32:35], s65 offen  lds
    s_add_u32 m0, s63, 4096
    s_add_u32 s65, s66, 36864
    buffer_load_dwordx4 v8, s[28:31], s65 offen  lds
    s_add_u32 m0, s63, 135168
    s_add_u32 s65, s67, 131072
    buffer_load_dwordx4 v9, s[32:35], s65 offen  lds
    s_add_u32 m0, s63, 8192
    s_add_u32 s65, s66, 73728
    buffer_load_dwordx4 v8, s[28:31], s65 offen  lds
    s_add_u32 m0, s63, 139264
    s_add_u32 s65, s67, 262144
    buffer_load_dwordx4 v9, s[32:35], s65 offen  lds
    s_add_u32 m0, s63, 12288
    s_add_u32 s65, s66, 110592
    buffer_load_dwordx4 v8, s[28:31], s65 offen  lds
    s_add_u32 m0, s63, 143360
    s_add_u32 s65, s67, 393216
    buffer_load_dwordx4 v9, s[32:35], s65 offen  lds
    s_add_u32 s64, s64, 1
    s_cmp_eq_u32 s64, 7
    s_cselect_b32 s64, 0, s64
    s_waitcnt vmcnt(8)
    s_barrier
    s_add_u32 m0, s63, 49152
    s_mov_b32 s65, 0
    buffer_load_dwordx4 v10, s[36:39], s65 offen nt lds
    s_add_u32 m0, s63, 53248
    s_mov_b32 s65, 4096
    buffer_load_dwordx4 v10, s[36:39], s65 offen nt lds
    s_add_u32 m0, s63, 57344
    s_mov_b32 s65, 8192
    buffer_load_dwordx4 v10, s[36:39], s65 offen nt lds
    s_add_u32 m0, s63, 61440
    s_mov_b32 s65, 12288
    buffer_load_dwordx4 v10, s[36:39], s65 offen nt lds
    s_waitcnt vmcnt(4)
    s_barrier
    s_add_u32 m0, s63, 32768
    s_mov_b32 s65, 16384
    buffer_load_dwordx4 v10, s[36:39], s65 offen nt lds
    s_add_u32 m0, s63, 36864
    s_mov_b32 s65, 20480
    buffer_load_dwordx4 v10, s[36:39], s65 offen nt lds
    s_add_u32 m0, s63, 40960
    s_mov_b32 s65, 24576
    buffer_load_dwordx4 v10, s[36:39], s65 offen nt lds
    s_add_u32 m0, s63, 45056
    s_mov_b32 s65, 28672
    buffer_load_dwordx4 v10, s[36:39], s65 offen nt lds
    s_add_u32 m0, s63, 98304
    s_mov_b32 s65, 0
    buffer_load_dwordx4 v11, s[40:43], s65 offen nt lds
    s_add_u32 m0, s63, 102400
    s_mov_b32 s65, 4096
    buffer_load_dwordx4 v11, s[40:43], s65 offen nt lds
    s_add_u32 m0, s63, 106496
    s_mov_b32 s65, 8192
    buffer_load_dwordx4 v11, s[40:43], s65 offen nt lds
    s_add_u32 m0, s63, 110592
    s_mov_b32 s65, 12288
    buffer_load_dwordx4 v11, s[40:43], s65 offen nt lds
    s_waitcnt vmcnt(8)
    s_barrier
    s_add_u32 m0, s63, 16384
    s_mov_b32 s65, 32768
    buffer_load_dwordx4 v10, s[36:39], s65 offen nt lds
    s_add_u32 m0, s63, 20480
    s_mov_b32 s65, 36864
    buffer_load_dwordx4 v10, s[36:39], s65 offen nt lds
    s_add_u32 m0, s63, 24576
    s_mov_b32 s65, 40960
    buffer_load_dwordx4 v10, s[36:39], s65 offen nt lds
    s_add_u32 m0, s63, 28672
    s_mov_b32 s65, 45056
    buffer_load_dwordx4 v10, s[36:39], s65 offen nt lds
    s_add_u32 m0, s63, 114688
    s_mov_b32 s65, 16384
    buffer_load_dwordx4 v11, s[40:43], s65 offen nt lds
    s_add_u32 m0, s63, 118784
    s_mov_b32 s65, 20480
    buffer_load_dwordx4 v11, s[40:43], s65 offen nt lds
    s_add_u32 m0, s63, 122880
    s_mov_b32 s65, 24576
    buffer_load_dwordx4 v11, s[40:43], s65 offen nt lds
    s_add_u32 m0, s63, 126976
    s_mov_b32 s65, 28672
    buffer_load_dwordx4 v11, s[40:43], s65 offen nt lds
    s_waitcnt vmcnt(8)
    s_barrier
    s_add_u32 m0, s63, 0
    s_mov_b32 s65, 49152
    buffer_load_dwordx4 v10, s[36:39], s65 offen nt lds
    s_add_u32 m0, s63, 4096
    s_mov_b32 s65, 53248
    buffer_load_dwordx4 v10, s[36:39], s65 offen nt lds
    s_add_u32 m0, s63, 8192
    s_mov_b32 s65, 57344
    buffer_load_dwordx4 v10, s[36:39], s65 offen nt lds
    s_add_u32 m0, s63, 12288
    s_mov_b32 s65, 61440
    buffer_load_dwordx4 v10, s[36:39], s65 offen nt lds
    s_add_u32 m0, s63, 131072
    s_mov_b32 s65, 32768
    buffer_load_dwordx4 v11, s[40:43], s65 offen nt lds
    s_add_u32 m0, s63, 135168
    s_mov_b32 s65, 36864
    buffer_load_dwordx4 v11, s[40:43], s65 offen nt lds
    s_add_u32 m0, s63, 139264
    s_mov_b32 s65, 40960
    buffer_load_dwordx4 v11, s[40:43], s65 offen nt lds
    s_add_u32 m0, s63, 143360
    s_mov_b32 s65, 45056
    buffer_load_dwordx4 v11, s[40:43], s65 offen nt lds
    v_add_u32 v1, 0, v0
    v_mul_u32_u24 v2, 3641, v1
    v_lshrrev_b32 v2, 16, v2
    v_mul_u32_u24 v3, 18, v2
    v_sub_u32 v1, v1, v3
    v_and_b32 v3, 3, v2
    v_bfe_u32 v4, v2, 4, 1
    v_lshl_add_u32 v3, v4, 2, v3
    v_bfe_u32 v4, v2, 3, 1
    v_lshl_add_u32 v3, v4, 3, v3
    v_bfe_u32 v4, v2, 2, 1
    v_lshl_add_u32 v3, v4, 4, v3
    v_mul_u32_u24 v3, 1152, v3
    v_lshl_add_u32 v12, v1, 4, v3

    v_add_u32 v1, 64, v0
    v_mul_u32_u24 v2, 3641, v1
    v_lshrrev_b32 v2, 16, v2
    v_mul_u32_u24 v3, 18, v2
    v_sub_u32 v1, v1, v3
    v_and_b32 v3, 3, v2
    v_bfe_u32 v4, v2, 4, 1
    v_lshl_add_u32 v3, v4, 2, v3
    s_branch L_b1
.p2align 12
L_t1:
    s_branch L_wc
    s_nop 0
L_b1:
    v_bfe_u32 v4, v2, 3, 1
    v_lshl_add_u32 v3, v4, 3, v3
    v_bfe_u32 v4, v2, 2, 1
    v_lshl_add_u32 v3, v4, 4, v3
    v_mul_u32_u24 v3, 1152, v3
    v_lshl_add_u32 v13, v1, 4, v3

    v_add_u32 v1, 128, v0
    v_mul_u32_u24 v2, 3641, v1
    v_lshrrev_b32 v2, 16, v2
    v_mul_u32_u24 v3, 18, v2
    v_sub_u32 v1, v1, v3
    v_and_b32 v3, 3, v2
    v_bfe_u32 v4, v2, 4, 1
    v_lshl_add_u32 v3, v4, 2, v3
    v_bfe_u32 v4, v2, 3, 1
    v_lshl_add_u32 v3, v4, 3, v3
    v_bfe_u32 v4, v2, 2, 1
    v_lshl_add_u32 v3, v4, 4, v3
    v_mul_u32_u24 v3, 1152, v3
    v_lshl_add_u32 v14, v1, 4, v3

    v_add_u32 v1, 192, v0
    v_mul_u32_u24 v2, 3641, v1
    v_lshrrev_b32 v2, 16, v2
    v_mul_u32_u24 v3, 18, v2
    v_sub_u32 v1, v1, v3
    v_and_b32 v3, 3, v2
    v_bfe_u32 v4, v2, 4, 1
    v_lshl_add_u32 v3, v4, 2, v3
    v_bfe_u32 v4, v2, 3, 1
    v_lshl_add_u32 v3, v4, 3, v3
    v_bfe_u32 v4, v2, 2, 1
    v_lshl_add_u32 v3, v4, 4, v3
    v_mul_u32_u24 v3, 1152, v3
    v_lshl_add_u32 v15, v1, 4, v3

    v_add_u32 v1, 256, v0
    v_mul_u32_u24 v2, 3641, v1
    v_lshrrev_b32 v2, 16, v2
    v_mul_u32_u24 v3, 18, v2
    v_sub_u32 v1, v1, v3
    v_and_b32 v3, 3, v2
    v_bfe_u32 v4, v2, 4, 1
    v_lshl_add_u32 v3, v4, 2, v3
    v_bfe_u32 v4, v2, 3, 1
    v_lshl_add_u32 v3, v4, 3, v3
    v_bfe_u32 v4, v2, 2, 1
    v_lshl_add_u32 v3, v4, 4, v3
    v_mul_u32_u24 v3, 1152, v3
    v_lshl_add_u32 v16, v1, 4, v3

    v_add_u32 v1, 320, v0
    v_mul_u32_u24 v2, 3641, v1
    v_lshrrev_b32 v2, 16, v2
    v_mul_u32_u24 v3, 18, v2
    v_sub_u32 v1, v1, v3
    v_and_b32 v3, 3, v2
    v_bfe_u32 v4, v2, 4, 1
    v_lshl_add_u32 v3, v4, 2, v3
    v_bfe_u32 v4, v2, 3, 1
    v_lshl_add_u32 v3, v4, 3, v3
    v_bfe_u32 v4, v2, 2, 1
    v_lshl_add_u32 v3, v4, 4, v3
    v_mul_u32_u24 v3, 1152, v3
    v_lshl_add_u32 v17, v1, 4, v3

    v_add_u32 v1, 384, v0
    v_mul_u32_u24 v2, 3641, v1
    v_lshrrev_b32 v2, 16, v2
    v_mul_u32_u24 v3, 18, v2
    v_sub_u32 v1, v1, v3
    v_and_b32 v3, 3, v2
    v_bfe_u32 v4, v2, 4, 1
    v_lshl_add_u32 v3, v4, 2, v3
    v_bfe_u32 v4, v2, 3, 1
    v_lshl_add_u32 v3, v4, 3, v3
    v_bfe_u32 v4, v2, 2, 1
    v_lshl_add_u32 v3, v4, 4, v3
    v_mul_u32_u24 v3, 1152, v3
    v_lshl_add_u32 v18, v1, 4, v3

    v_add_u32 v1, 448, v0
    v_mul_u32_u24 v2, 3641, v1
    v_lshrrev_b32 v2, 16, v2
    v_mul_u32_u24 v3, 18, v2
    v_sub_u32 v1, v1, v3
    v_and_b32 v3, 3, v2
    v_bfe_u32 v4, v2, 4, 1
    v_lshl_add_u32 v3, v4, 2, v3
    v_bfe_u32 v4, v2, 3, 1
    v_lshl_add_u32 v3, v4, 3, v3
    v_bfe_u32 v4, v2, 2, 1
    v_lshl_add_u32 v3, v4, 4, v3
    v_mul_u32_u24 v3, 1152, v3
    v_lshl_add_u32 v19, v1, 4, v3

    v_add_u32 v1, 512, v0
    v_mul_u32_u24 v2, 3641, v1
    v_lshrrev_b32 v2, 16, v2
    v_mul_u32_u24 v3, 18, v2
    v_sub_u32 v1, v1, v3
    v_and_b32 v3, 3, v2
    v_bfe_u32 v4, v2, 4, 1
    v_lshl_add_u32 v3, v4, 2, v3
    v_bfe_u32 v4, v2, 3, 1
    v_lshl_add_u32 v3, v4, 3, v3
    v_bfe_u32 v4, v2, 2, 1
    v_lshl_add_u32 v3, v4, 4, v3
    v_mul_u32_u24 v3, 1152, v3
    v_lshl_add_u32 v20, v1, 4, v3

    s_waitcnt vmcnt(8)
    s_barrier
    s_add_u32 m0, s63, 49152
    s_mov_b32 s65, 65536
    buffer_load_dwordx4 v10, s[36:39], s65 offen nt lds
    s_add_u32 m0, s63, 53248
    s_mov_b32 s65, 69632
    buffer_load_dwordx4 v10, s[36:39], s65 offen nt lds
    s_add_u32 m0, s63, 57344
    s_mov_b32 s65, 73728
    buffer_load_dwordx4 v10, s[36:39], s65 offen nt lds
    s_add_u32 m0, s63, 61440
    s_mov_b32 s65, 77824
    buffer_load_dwordx4 v10, s[36:39], s65 offen nt lds
    s_add_u32 m0, s63, 147456
    s_mov_b32 s65, 49152
    buffer_load_dwordx4 v11, s[40:43], s65 offen nt lds
    s_add_u32 m0, s63, 151552
    s_mov_b32 s65, 53248
    buffer_load_dwordx4 v11, s[40:43], s65 offen nt lds
    s_add_u32 m0, s63, 155648
    s_mov_b32 s65, 57344
    buffer_load_dwordx4 v11, s[40:43], s65 offen nt lds
    s_add_u32 m0, s63, 159744
    s_mov_b32 s65, 61440
    buffer_load_dwordx4 v11, s[40:43], s65 offen nt lds
    buffer_load_dword v32, off, s[48:51], s60 sc1
    buffer_load_dword v32, off, s[48:51], s61 sc1
    s_waitcnt vmcnt(10)
    s_barrier
    s_add_u32 m0, s63, 32768
    s_mov_b32 s65, 81920
    buffer_load_dwordx4 v10, s[36:39], s65 offen nt lds
    s_add_u32 m0, s63, 36864
    s_mov_b32 s65, 86016
    buffer_load_dwordx4 v10, s[36:39], s65 offen nt lds
    s_add_u32 m0, s63, 40960
    s_mov_b32 s65, 90112
    buffer_load_dwordx4 v10, s[36:39], s65 offen nt lds
    s_add_u32 m0, s63, 45056
    s_mov_b32 s65, 94208
    buffer_load_dwordx4 v10, s[36:39], s65 offen nt lds
    s_add_u32 m0, s63, 98304
    s_mov_b32 s65, 65536
    buffer_load_dwordx4 v11, s[40:43], s65 offen nt lds
    s_add_u32 m0, s63, 102400
    s_mov_b32 s65, 69632
    buffer_load_dwordx4 v11, s[40:43], s65 offen nt lds
    s_add_u32 m0, s63, 106496
    s_mov_b32 s65, 73728
    buffer_load_dwordx4 v11, s[40:43], s65 offen nt lds
    s_add_u32 m0, s63, 110592
    s_mov_b32 s65, 77824
    buffer_load_dwordx4 v11, s[40:43], s65 offen nt lds
    s_waitcnt vmcnt(10)
    s_barrier
    s_add_u32 m0, s63, 16384
    s_mov_b32 s65, 98304
    buffer_load_dwordx4 v10, s[36:39], s65 offen nt lds
    s_add_u32 m0, s63, 20480
    s_mov_b32 s65, 102400
    buffer_load_dwordx4 v10, s[36:39], s65 offen nt lds
    s_add_u32 m0, s63, 24576
    s_mov_b32 s65, 106496
    buffer_load_dwordx4 v10, s[36:39], s65 offen nt lds
    s_add_u32 m0, s63, 28672
    s_mov_b32 s65, 110592
    buffer_load_dwordx4 v10, s[36:39], s65 offen nt lds
    s_add_u32 m0, s63, 114688
    s_mov_b32 s65, 81920
    buffer_load_dwordx4 v11, s[40:43], s65 offen nt lds
    s_add_u32 m0, s63, 118784
    s_mov_b32 s65, 86016
    buffer_load_dwordx4 v11, s[40:43], s65 offen nt lds
    s_add_u32 m0, s63, 122880
    s_mov_b32 s65, 90112
    buffer_load_dwordx4 v11, s[40:43], s65 offen nt lds
    s_add_u32 m0, s63, 126976
    s_mov_b32 s65, 94208
    buffer_load_dwordx4 v11, s[40:43], s65 offen nt lds
    buffer_load_dwordx4 v[32:35], v22, s[44:47], s62 offen offset:0
    buffer_load_dwordx4 v[32:35], v22, s[44:47], s62 offen offset:1024
    buffer_load_dwordx4 v[32:35], v22, s[44:47], s62 offen offset:2048
    buffer_load_dwordx4 v[32:35], v22, s[44:47], s62 offen offset:3072
    s_mov_b32 exec_hi, 0
    buffer_load_dwordx4 v[32:35], v23, s[44:47], s62 offen
    s_mov_b64 exec, -1
    s_waitcnt vmcnt(13)
    s_barrier
    s_add_u32 m0, s63, 0
    s_mov_b32 s65, 114688
    buffer_load_dwordx4 v10, s[36:39], s65 offen nt lds
    s_add_u32 m0, s63, 4096
    s_mov_b32 s65, 118784
    buffer_load_dwordx4 v10, s[36:39], s65 offen nt lds
    s_add_u32 m0, s63, 8192
    s_mov_b32 s65, 122880
    buffer_load_dwordx4 v10, s[36:39], s65 offen nt lds
    s_add_u32 m0, s63, 12288
    s_mov_b32 s65, 126976
    buffer_load_dwordx4 v10, s[36:39], s65 offen nt lds
    s_add_u32 m0, s63, 131072
    s_mov_b32 s65, 98304
    buffer_load_dwordx4 v11, s[40:43], s65 offen nt lds
    s_add_u32 m0, s63, 135168
    s_mov_b32 s65, 102400
    buffer_load_dwordx4 v11, s[40:43], s65 offen nt lds
    s_add_u32 m0, s63, 139264
    s_mov_b32 s65, 106496
    buffer_load_dwordx4 v11, s[40:43], s65 offen nt lds
    s_add_u32 m0, s63, 143360
    s_mov_b32 s65, 110592
    buffer_load_dwordx4 v11, s[40:43], s65 offen nt lds
    s_waitcnt vmcnt(13)
    s_barrier
    s_add_u32 m0, s63, 147456
    s_mov_b32 s65, 114688
    buffer_load_dwordx4 v11, s[40:43], s65 offen nt lds
    s_add_u32 m0, s63, 151552
    s_mov_b32 s65, 118784
    buffer_load_dwordx4 v11, s[40:43], s65 offen nt lds
    s_add_u32 m0, s63, 155648
    s_mov_b32 s65, 122880
    buffer_load_dwordx4 v11, s[40:43], s65 offen nt lds
    s_add_u32 m0, s63, 159744
    s_mov_b32 s65, 126976
    buffer_load_dwordx4 v11, s[40:43], s65 offen nt lds
    s_and_b32 s3, s25, 1
    s_lshr_b32 s65, s25, 1
    s_mul_i32 s60, s65, 2
    s_add_u32 s60, s60, s3
    s_add_u32 s60, s60, 6
    s_mul_i32 s60, s60, 9216
    s_mul_i32 s61, s65, 6
    s_add_u32 s61, s61, s3
    s_add_u32 s61, s61, 4
    s_mul_i32 s61, s61, 9216
    s_mul_i32 s62, s65, 10
    s_add_u32 s62, s62, s3
    s_add_u32 s62, s62, 2
    s_mul_i32 s62, s62, 9216
    s_mul_i32 s63, s65, 14
    s_add_u32 s63, s63, s3
    s_add_u32 s63, s63, 0
    s_mul_i32 s63, s63, 9216
    s_mul_i32 s65, s24, 288
    s_add_u32 s3, s24, 0
    s_and_b32 s3, s3, 3
    s_lshl2_add_u32 s3, s23, s3
    s_lshl2_add_u32 s3, s3, s25
    s_mul_i32 s3, s3, 36864
    s_add_u32 s66, s3, s65
    s_add_u32 s3, s24, 1
    s_and_b32 s3, s3, 3
    s_lshl2_add_u32 s3, s23, s3
    s_lshl2_add_u32 s3, s3, s25
    s_mul_i32 s3, s3, 36864
    s_add_u32 s67, s3, s65
    s_add_u32 s3, s24, 2
    s_and_b32 s3, s3, 3
    s_lshl2_add_u32 s3, s23, s3
    s_lshl2_add_u32 s3, s3, s25
    s_mul_i32 s3, s3, 36864
    s_add_u32 s68, s3, s65
    s_add_u32 s3, s24, 3
    s_and_b32 s3, s3, 3
    s_lshl2_add_u32 s3, s23, s3
    s_lshl2_add_u32 s3, s3, s25
    s_mul_i32 s3, s3, 36864
    s_add_u32 s69, s3, s65
    s_add_u32 m0, s60, 0
    s_nop 0
    buffer_load_dwordx4 v12, s[44:47], s66 offen lds
    s_add_u32 m0, s60, 1024
    s_nop 0
    buffer_load_dwordx4 v13, s[44:47], s66 offen lds
    s_add_u32 m0, s60, 2048
    s_nop 0
    buffer_load_dwordx4 v14, s[44:47], s66 offen lds
    s_add_u32 m0, s60, 3072
    s_nop 0
    buffer_load_dwordx4 v15, s[44:47], s66 offen lds
    s_add_u32 m0, s60, 4096
    s_nop 0
    buffer_load_dwordx4 v16, s[44:47], s66 offen lds
    s_add_u32 m0, s60, 5120
    s_nop 0
    buffer_load_dwordx4 v17, s[44:47], s66 offen lds
    s_add_u32 m0, s60, 6144
    s_nop 0
    buffer_load_dwordx4 v18, s[44:47], s66 offen lds
    s_add_u32 m0, s60, 7168
    s_nop 0
    buffer_load_dwordx4 v19, s[44:47], s66 offen lds
    s_add_u32 m0, s60, 8192
    s_nop 0
    buffer_load_dwordx4 v20, s[44:47], s66 offen lds
    s_waitcnt vmcnt(13)
    s_barrier
    s_add_u32 m0, s61, 0
    s_nop 0
    buffer_load_dwordx4 v12, s[44:47], s67 offen lds
    s_add_u32 m0, s61, 1024
    s_nop 0
    buffer_load_dwordx4 v13, s[44:47], s67 offen lds
    s_add_u32 m0, s61, 2048
    s_nop 0
    buffer_load_dwordx4 v14, s[44:47], s67 offen lds
    s_add_u32 m0, s61, 3072
    s_nop 0
    buffer_load_dwordx4 v15, s[44:47], s67 offen lds
    s_add_u32 m0, s61, 4096
    s_nop 0
    buffer_load_dwordx4 v16, s[44:47], s67 offen lds
    s_add_u32 m0, s61, 5120
    s_nop 0
    buffer_load_dwordx4 v17, s[44:47], s67 offen lds
    s_add_u32 m0, s61, 6144
    s_nop 0
    buffer_load_dwordx4 v18, s[44:47], s67 offen lds
    s_add_u32 m0, s61, 7168
    s_nop 0
    buffer_load_dwordx4 v19, s[44:47], s67 offen lds
    s_add_u32 m0, s61, 8192
    s_nop 0
    buffer_load_dwordx4 v20, s[44:47], s67 offen lds
    buffer_load_dword v32, v24, s[48:51], s95 offen
    s_waitcnt vmcnt(19)
    s_barrier
    s_add_u32 m0, s62, 0
    s_nop 0
    buffer_load_dwordx4 v12, s[44:47], s68 offen lds
    s_add_u32 m0, s62, 1024
    s_nop 0
    buffer_load_dwordx4 v13, s[44:47], s68 offen lds
    s_add_u32 m0, s62, 2048
    s_nop 0
    buffer_load_dwordx4 v14, s[44:47], s68 offen lds
    s_add_u32 m0, s62, 3072
    s_nop 0
    buffer_load_dwordx4 v15, s[44:47], s68 offen lds
    s_add_u32 m0, s62, 4096
    s_nop 0
    buffer_load_dwordx4 v16, s[44:47], s68 offen lds
    s_add_u32 m0, s62, 5120
    s_nop 0
    buffer_load_dwordx4 v17, s[44:47], s68 offen lds
    s_add_u32 m0, s62, 6144
    s_nop 0
    buffer_load_dwordx4 v18, s[44:47], s68 offen lds
    s_add_u32 m0, s62, 7168
    s_nop 0
    buffer_load_dwordx4 v19, s[44:47], s68 offen lds
    s_add_u32 m0, s62, 8192
    s_nop 0
    buffer_load_dwordx4 v20, s[44:47], s68 offen lds
    s_waitcnt vmcnt(10)
    s_barrier
    s_add_u32 m0, s63, 0
    s_nop 0
    buffer_load_dwordx4 v12, s[44:47], s69 offen lds
    s_add_u32 m0, s63, 1024
    s_nop 0
    buffer_load_dwordx4 v13, s[44:47], s69 offen lds
    s_add_u32 m0, s63, 2048
    s_nop 0
    buffer_load_dwordx4 v14, s[44:47], s69 offen lds
    s_add_u32 m0, s63, 3072
    s_nop 0
    buffer_load_dwordx4 v15, s[44:47], s69 offen lds
    s_add_u32 m0, s63, 4096
    s_nop 0
    buffer_load_dwordx4 v16, s[44:47], s69 offen lds
    s_add_u32 m0, s63, 5120
    s_nop 0
    buffer_load_dwordx4 v17, s[44:47], s69 offen lds
    s_add_u32 m0, s63, 6144
    s_nop 0
    buffer_load_dwordx4 v18, s[44:47], s69 offen lds
    s_add_u32 m0, s63, 7168
    s_nop 0
    buffer_load_dwordx4 v19, s[44:47], s69 offen lds
    s_add_u32 m0, s63, 8192
    s_nop 0
    buffer_load_dwordx4 v20, s[44:47], s69 offen lds
    s_waitcnt vmcnt(9)
    s_barrier
    s_waitcnt vmcnt(0)
    s_barrier
    v_and_b32 v1, 7, v0
    v_lshlrev_b32 v1, 3, v1
    s_lshl_b32 s3, s25, 2
    s_lshr_b32 s3, 8448, s3
    s_and_b32 s3, s3, 15
    s_lshl_b32 s3, s3, 7
    s_add_u32 s66, s3, s94
    s_lshl2_add_u32 s60, s27, s24
    s_mul_i32 s60, s60, 36864
    s_add_u32 s60, s60, 8388608
    s_lshl_b32 s61, s25, 10
    v_lshl_add_u32 v4, v0, 4, s61
    v_lshlrev_b32 v5, 3, v0
    v_add_u32 v5, 4096, v5
    s_mul_i32 s62, s27, 18432
    s_mul_i32 s61, s24, 288
    s_add_u32 s62, s62, s61
    s_lshl_b32 s61, s25, 6
    s_add_u32 s63, s62, s61
    v_and_b32 v6, 15, v0
    v_mul_u32_u24 v6, 1152, v6
    v_lshrrev_b32 v7, 4, v0
    v_lshl_add_u32 v6, v7, 3, v6
    s_mov_b32 s64, 0xffff0000

    s_mov_b32 s3, 262144
    s_mov_b32 s67, 0
    s_mov_b32 s68, 0xff
    s_cmp_lg_u32 s67, 0
    s_cbranch_scc1 L_have40
L_poll40:
    buffer_load_dwordx2 v[2:3], v1, s[48:51], s66 offen sc1
    s_sub_u32 s3, s3, 1
    s_cselect_b32 s69, -1, 0
    s_waitcnt vmcnt(0)
    v_cmp_eq_u64 vcc, v[2:3], v[252:253]
    s_or_b32 s69, s69, vcc_lo
    s_and_b32 s67, s69, s68
    s_cbranch_scc0 L_poll40
    s_andn2_b32 s68, s68, s67
L_have40:
    s_ff1_i32_b32 s69, s67
    s_bitset0_b32 s67, s69
    s_mul_i32 s69, s69, 4608
    s_add_u32 s4, s60, s69
    buffer_load_dwordx4 v[32:35], v4, s[48:51], s4 offen sc1

    s_cmp_lg_u32 s67, 0
    s_cbranch_scc1 L_have41
L_poll41:
    buffer_load_dwordx2 v[2:3], v1, s[48:51], s66 offen sc1
    s_sub_u32 s3, s3, 1
    s_cselect_b32 s69, -1, 0
    s_waitcnt vmcnt(0)
    v_cmp_eq_u64 vcc, v[2:3], v[252:253]
    s_or_b32 s69, s69, vcc_lo
    s_and_b32 s67, s69, s68
    s_cbranch_scc0 L_poll41
    s_andn2_b32 s68, s68, s67
L_have41:
    s_ff1_i32_b32 s69, s67
    s_bitset0_b32 s67, s69
    s_mul_i32 s69, s69, 4608
    s_add_u32 s5, s60, s69
    buffer_load_dwordx4 v[36:39], v4, s[48:51], s5 offen sc1

    s_cmp_lg_u32 s67, 0
    s_cbranch_scc1 L_have42
L_poll42:
    buffer_load_dwordx2 v[2:3], v1, s[48:51], s66 offen sc1
    s_sub_u32 s3, s3, 1
    s_cselect_b32 s69, -1, 0
    s_waitcnt vmcnt(0)
    v_cmp_eq_u64 vcc, v[2:3], v[252:253]
    s_or_b32 s69, s69, vcc_lo
    s_and_b32 s67, s69, s68
    s_cbranch_scc0 L_poll42
    s_andn2_b32 s68, s68, s67
L_have42:
    s_ff1_i32_b32 s69, s67
    s_bitset0_b32 s67, s69
    s_mul_i32 s69, s69, 4608
    s_add_u32 s6, s60, s69
    buffer_load_dwordx4 v[40:43], v4, s[48:51], s6 offen sc1

    s_cmp_lg_u32 s67, 0
    s_cbranch_scc1 L_have43
L_poll43:
    buffer_load_dwordx2 v[2:3], v1, s[48:51], s66 offen sc1
    s_sub_u32 s3, s3, 1
    s_cselect_b32 s69, -1, 0
    s_waitcnt vmcnt(0)
    v_cmp_eq_u64 vcc, v[2:3], v[252:253]
    s_or_b32 s69, s69, vcc_lo
    s_and_b32 s67, s69, s68
    s_cbranch_scc0 L_poll43
    s_andn2_b32 s68, s68, s67
L_have43:
    s_ff1_i32_b32 s69, s67
    s_bitset0_b32 s67, s69
    s_mul_i32 s69, s69, 4608
    s_add_u32 s7, s60, s69
    buffer_load_dwordx4 v[44:47], v4, s[48:51], s7 offen sc1

    s_cmp_lg_u32 s67, 0
    s_cbranch_scc1 L_have44
L_poll44:
    buffer_load_dwordx2 v[2:3], v1, s[48:51], s66 offen sc1
    s_sub_u32 s3, s3, 1
    s_cselect_b32 s69, -1, 0
    s_waitcnt vmcnt(0)
    v_cmp_eq_u64 vcc, v[2:3], v[252:253]
    s_or_b32 s69, s69, vcc_lo
    s_and_b32 s67, s69, s68
    s_cbranch_scc0 L_poll44
    s_andn2_b32 s68, s68, s67
L_have44:
    s_ff1_i32_b32 s69, s67
    s_bitset0_b32 s67, s69
    s_mul_i32 s69, s69, 4608
    s_add_u32 s8, s60, s69
    buffer_load_dwordx4 v[48:51], v4, s[48:51], s8 offen sc1

    s_cmp_lg_u32 s67, 0
    s_cbranch_scc1 L_have45
L_poll45:
    buffer_load_dwordx2 v[2:3], v1, s[48:51], s66 offen sc1
    s_sub_u32 s3, s3, 1
    s_cselect_b32 s69, -1, 0
    s_waitcnt vmcnt(0)
    v_cmp_eq_u64 vcc, v[2:3], v[252:253]
    s_or_b32 s69, s69, vcc_lo
    s_and_b32 s67, s69, s68
    s_cbranch_scc0 L_poll45
    s_andn2_b32 s68, s68, s67
L_have45:
    s_ff1_i32_b32 s69, s67
    s_bitset0_b32 s67, s69
    s_mul_i32 s69, s69, 4608
    s_add_u32 s9, s60, s69
    buffer_load_dwordx4 v[52:55], v4, s[48:51], s9 offen sc1

    s_cmp_lg_u32 s67, 0
    s_cbranch_scc1 L_have46
L_poll46:
    buffer_load_dwordx2 v[2:3], v1, s[48:51], s66 offen sc1
    s_sub_u32 s3, s3, 1
    s_cselect_b32 s69, -1, 0
    s_waitcnt vmcnt(0)
    v_cmp_eq_u64 vcc, v[2:3], v[252:253]
    s_or_b32 s69, s69, vcc_lo
    s_and_b32 s67, s69, s68
    s_cbranch_scc0 L_poll46
    s_andn2_b32 s68, s68, s67
L_have46:
    s_ff1_i32_b32 s69, s67
    s_bitset0_b32 s67, s69
    s_mul_i32 s69, s69, 4608
    s_add_u32 s10, s60, s69
    buffer_load_dwordx4 v[56:59], v4, s[48:51], s10 offen sc1

    s_cmp_lg_u32 s67, 0
    s_cbranch_scc1 L_have47
L_poll47:
    buffer_load_dwordx2 v[2:3], v1, s[48:51], s66 offen sc1
    s_sub_u32 s3, s3, 1
    s_cselect_b32 s69, -1, 0
    s_waitcnt vmcnt(0)
    v_cmp_eq_u64 vcc, v[2:3], v[252:253]
    s_or_b32 s69, s69, vcc_lo
    s_and_b32 s67, s69, s68
    s_cbranch_scc0 L_poll47
    s_andn2_b32 s68, s68, s67
L_have47:
    s_ff1_i32_b32 s69, s67
    s_bitset0_b32 s67, s69
    s_mul_i32 s69, s69, 4608
    s_add_u32 s11, s60, s69
    buffer_load_dwordx4 v[60:63], v4, s[48:51], s11 offen sc1

    s_waitcnt vmcnt(7)
    v_lshlrev_b32 v24, 16, v32
    v_and_b32 v25, s64, v32
    v_lshlrev_b32 v26, 16, v33
    v_and_b32 v27, s64, v33
    v_lshlrev_b32 v28, 16, v34
    v_and_b32 v29, s64, v34
    v_lshlrev_b32 v30, 16, v35
    v_and_b32 v31, s64, v35
    s_waitcnt vmcnt(6)
    v_lshlrev_b32 v2, 16, v36
    v_and_b32 v3, s64, v36
    v_pk_add_f32 v[24:25], v[24:25], v[2:3]
    v_lshlrev_b32 v2, 16, v37
    v_and_b32 v3, s64, v37
    v_pk_add_f32 v[26:27], v[26:27], v[2:3]
    v_lshlrev_b32 v2, 16, v38
    v_and_b32 v3, s64, v38
    v_pk_add_f32 v[28:29], v[28:29], v[2:3]
    v_lshlrev_b32 v2, 16, v39
    v_and_b32 v3, s64, v39
    v_pk_add_f32 v[30:31], v[30:31], v[2:3]
    s_waitcnt vmcnt(5)
    v_lshlrev_b32 v2, 16, v40
    v_and_b32 v3, s64, v40
    v_pk_add_f32 v[24:25], v[24:25], v[2:3]
    v_lshlrev_b32 v2, 16, v41
    v_and_b32 v3, s64, v41
    v_pk_add_f32 v[26:27], v[26:27], v[2:3]
    v_lshlrev_b32 v2, 16, v42
    v_and_b32 v3, s64, v42
    v_pk_add_f32 v[28:29], v[28:29], v[2:3]
    v_lshlrev_b32 v2, 16, v43
    v_and_b32 v3, s64, v43
    v_pk_add_f32 v[30:31], v[30:31], v[2:3]
    s_waitcnt vmcnt(4)
    v_lshlrev_b32 v2, 16, v44
    v_and_b32 v3, s64, v44
    v_pk_add_f32 v[24:25], v[24:25], v[2:3]
    v_lshlrev_b32 v2, 16, v45
    v_and_b32 v3, s64, v45
    v_pk_add_f32 v[26:27], v[26:27], v[2:3]
    v_lshlrev_b32 v2, 16, v46
    v_and_b32 v3, s64, v46
    v_pk_add_f32 v[28:29], v[28:29], v[2:3]
    v_lshlrev_b32 v2, 16, v47
    v_and_b32 v3, s64, v47
    v_pk_add_f32 v[30:31], v[30:31], v[2:3]
    s_waitcnt vmcnt(3)
    v_lshlrev_b32 v2, 16, v48
    v_and_b32 v3, s64, v48
    v_pk_add_f32 v[24:25], v[24:25], v[2:3]
    v_lshlrev_b32 v2, 16, v49
    v_and_b32 v3, s64, v49
    v_pk_add_f32 v[26:27], v[26:27], v[2:3]
    v_lshlrev_b32 v2, 16, v50
    v_and_b32 v3, s64, v50
    v_pk_add_f32 v[28:29], v[28:29], v[2:3]
    v_lshlrev_b32 v2, 16, v51
    v_and_b32 v3, s64, v51
    v_pk_add_f32 v[30:31], v[30:31], v[2:3]
    s_waitcnt vmcnt(2)
    v_lshlrev_b32 v2, 16, v52
    v_and_b32 v3, s64, v52
    v_pk_add_f32 v[24:25], v[24:25], v[2:3]
    v_lshlrev_b32 v2, 16, v53
    v_and_b32 v3, s64, v53
    v_pk_add_f32 v[26:27], v[26:27], v[2:3]
    v_lshlrev_b32 v2, 16, v54
    v_and_b32 v3, s64, v54
    v_pk_add_f32 v[28:29], v[28:29], v[2:3]
    v_lshlrev_b32 v2, 16, v55
    v_and_b32 v3, s64, v55
    v_pk_add_f32 v[30:31], v[30:31], v[2:3]
    s_waitcnt vmcnt(1)
    v_lshlrev_b32 v2, 16, v56
    v_and_b32 v3, s64, v56
    v_pk_add_f32 v[24:25], v[24:25], v[2:3]
    v_lshlrev_b32 v2, 16, v57
    v_and_b32 v3, s64, v57
    v_pk_add_f32 v[26:27], v[26:27], v[2:3]
    v_lshlrev_b32 v2, 16, v58
    v_and_b32 v3, s64, v58
    v_pk_add_f32 v[28:29], v[28:29], v[2:3]
    v_lshlrev_b32 v2, 16, v59
    v_and_b32 v3, s64, v59
    v_pk_add_f32 v[30:31], v[30:31], v[2:3]
    s_waitcnt vmcnt(0)
    v_lshlrev_b32 v2, 16, v60
    v_and_b32 v3, s64, v60
    v_pk_add_f32 v[24:25], v[24:25], v[2:3]
    v_lshlrev_b32 v2, 16, v61
    v_and_b32 v3, s64, v61
    v_pk_add_f32 v[26:27], v[26:27], v[2:3]
    v_lshlrev_b32 v2, 16, v62
    v_and_b32 v3, s64, v62
    v_pk_add_f32 v[28:29], v[28:29], v[2:3]
    v_lshlrev_b32 v2, 16, v63
    v_and_b32 v3, s64, v63
    v_pk_add_f32 v[30:31], v[30:31], v[2:3]
    v_cvt_pk_bf16_f32 v24, v24, v25
    v_cvt_pk_bf16_f32 v25, v26, v27
    v_cvt_pk_bf16_f32 v26, v28, v29
    v_cvt_pk_bf16_f32 v27, v30, v31
    buffer_store_dwordx2 v[24:25], v6, s[52:55], s63 offen offset:0
    buffer_store_dwordx2 v[26:27], v6, s[52:55], s63 offen offset:32
    s_branch L_fin
L_p3b:
    s_mov_b32 s3, 262144
    s_mov_b32 s67, 0
    s_mov_b32 s68, 0xff
    s_cmp_lg_u32 s67, 0
    s_cbranch_scc1 L_have20
L_poll20:
    buffer_load_dwordx2 v[2:3], v1, s[48:51], s66 offen sc1
    s_sub_u32 s3, s3, 1
    s_cselect_b32 s69, -1, 0
    s_waitcnt vmcnt(0)
    v_cmp_eq_u64 vcc, v[2:3], v[252:253]
    s_or_b32 s69, s69, vcc_lo
    s_and_b32 s67, s69, s68
    s_cbranch_scc0 L_poll20
    s_andn2_b32 s68, s68, s67
L_have20:
    s_ff1_i32_b32 s69, s67
    s_bitset0_b32 s67, s69
    s_mul_i32 s69, s69, 4608
    s_add_u32 s4, s60, s69
    buffer_load_dwordx2 v[32:33], v5, s[48:51], s4 offen sc1

    s_cmp_lg_u32 s67, 0
    s_cbranch_scc1 L_have21
L_poll21:
    buffer_load_dwordx2 v[2:3], v1, s[48:51], s66 offen sc1
    s_sub_u32 s3, s3, 1
    s_cselect_b32 s69, -1, 0
L_t2:
    s_cmp_eq_u32 s100, 1
    s_cbranch_scc1 L_t5
    s_waitcnt vmcnt(0)
    v_cmp_eq_u64 vcc, v[2:3], v[252:253]
    s_or_b32 s69, s69, vcc_lo
    s_and_b32 s67, s69, s68
    s_cbranch_scc0 L_poll21
    s_andn2_b32 s68, s68, s67
L_have21:
    s_ff1_i32_b32 s69, s67
    s_bitset0_b32 s67, s69
    s_mul_i32 s69, s69, 4608
    s_add_u32 s5, s60, s69
    buffer_load_dwordx2 v[34:35], v5, s[48:51], s5 offen sc1

    s_cmp_lg_u32 s67, 0
    s_cbranch_scc1 L_have22
L_poll22:
    buffer_load_dwordx2 v[2:3], v1, s[48:51], s66 offen sc1
    s_sub_u32 s3, s3, 1
    s_cselect_b32 s69, -1, 0
    s_waitcnt vmcnt(0)
    v_cmp_eq_u64 vcc, v[2:3], v[252:253]
    s_or_b32 s69, s69, vcc_lo
    s_and_b32 s67, s69, s68
    s_cbranch_scc0 L_poll22
    s_andn2_b32 s68, s68, s67
L_have22:
    s_ff1_i32_b32 s69, s67
    s_bitset0_b32 s67, s69
    s_mul_i32 s69, s69, 4608
    s_add_u32 s6, s60, s69
    buffer_load_dwordx2 v[36:37], v5, s[48:51], s6 offen sc1

    s_cmp_lg_u32 s67, 0
    s_cbranch_scc1 L_have23
L_poll23:
    buffer_load_dwordx2 v[2:3], v1, s[48:51], s66 offen sc1
    s_sub_u32 s3, s3, 1
    s_cselect_b32 s69, -1, 0
    s_waitcnt vmcnt(0)
    v_cmp_eq_u64 vcc, v[2:3], v[252:253]
    s_or_b32 s69, s69, vcc_lo
    s_and_b32 s67, s69, s68
    s_cbranch_scc0 L_poll23
    s_andn2_b32 s68, s68, s67
L_have23:
    s_ff1_i32_b32 s69, s67
    s_bitset0_b32 s67, s69
    s_mul_i32 s69, s69, 4608
    s_add_u32 s7, s60, s69
    buffer_load_dwordx2 v[38:39], v5, s[48:51], s7 offen sc1

    s_cmp_lg_u32 s67, 0
    s_cbranch_scc1 L_have24
L_poll24:
    buffer_load_dwordx2 v[2:3], v1, s[48:51], s66 offen sc1
    s_sub_u32 s3, s3, 1
    s_cselect_b32 s69, -1, 0
    s_waitcnt vmcnt(0)
    v_cmp_eq_u64 vcc, v[2:3], v[252:253]
    s_or_b32 s69, s69, vcc_lo
    s_and_b32 s67, s69, s68
    s_cbranch_scc0 L_poll24
    s_andn2_b32 s68, s68, s67
L_have24:
    s_ff1_i32_b32 s69, s67
    s_bitset0_b32 s67, s69
    s_mul_i32 s69, s69, 4608
    s_add_u32 s8, s60, s69
    buffer_load_dwordx2 v[40:41], v5, s[48:51], s8 offen sc1

    s_cmp_lg_u32 s67, 0
    s_cbranch_scc1 L_have25
L_poll25:
    buffer_load_dwordx2 v[2:3], v1, s[48:51], s66 offen sc1
    s_sub_u32 s3, s3, 1
    s_cselect_b32 s69, -1, 0
    s_waitcnt vmcnt(0)
    v_cmp_eq_u64 vcc, v[2:3], v[252:253]
    s_or_b32 s69, s69, vcc_lo
    s_and_b32 s67, s69, s68
    s_cbranch_scc0 L_poll25
    s_andn2_b32 s68, s68, s67
L_have25:
    s_ff1_i32_b32 s69, s67
    s_bitset0_b32 s67, s69
    s_mul_i32 s69, s69, 4608
    s_add_u32 s9, s60, s69
    buffer_load_dwordx2 v[42:43], v5, s[48:51], s9 offen sc1

    s_cmp_lg_u32 s67, 0
    s_cbranch_scc1 L_have26
L_poll26:
    buffer_load_dwordx2 v[2:3], v1, s[48:51], s66 offen sc1
    s_sub_u32 s3, s3, 1
    s_cselect_b32 s69, -1, 0
    s_waitcnt vmcnt(0)
    v_cmp_eq_u64 vcc, v[2:3], v[252:253]
    s_or_b32 s69, s69, vcc_lo
    s_and_b32 s67, s69, s68
    s_cbranch_scc0 L_poll26
    s_andn2_b32 s68, s68, s67
L_have26:
    s_ff1_i32_b32 s69, s67
    s_bitset0_b32 s67, s69
    s_mul_i32 s69, s69, 4608
    s_add_u32 s10, s60, s69
    buffer_load_dwordx2 v[44:45], v5, s[48:51], s10 offen sc1

    s_cmp_lg_u32 s67, 0
    s_cbranch_scc1 L_have27
L_poll27:
    buffer_load_dwordx2 v[2:3], v1, s[48:51], s66 offen sc1
    s_sub_u32 s3, s3, 1
    s_cselect_b32 s69, -1, 0
    s_waitcnt vmcnt(0)
    v_cmp_eq_u64 vcc, v[2:3], v[252:253]
    s_or_b32 s69, s69, vcc_lo
    s_and_b32 s67, s69, s68
    s_cbranch_scc0 L_poll27
    s_andn2_b32 s68, s68, s67
L_have27:
    s_ff1_i32_b32 s69, s67
    s_bitset0_b32 s67, s69
    s_mul_i32 s69, s69, 4608
    s_add_u32 s11, s60, s69
    buffer_load_dwordx2 v[46:47], v5, s[48:51], s11 offen sc1

    s_waitcnt vmcnt(7)
    v_lshlrev_b32 v24, 16, v32
    v_and_b32 v25, s64, v32
    v_lshlrev_b32 v26, 16, v33
    v_and_b32 v27, s64, v33
    s_waitcnt vmcnt(6)
    v_lshlrev_b32 v2, 16, v34
    v_and_b32 v3, s64, v34
    v_pk_add_f32 v[24:25], v[24:25], v[2:3]
    v_lshlrev_b32 v2, 16, v35
    v_and_b32 v3, s64, v35
    v_pk_add_f32 v[26:27], v[26:27], v[2:3]
    s_waitcnt vmcnt(5)
    v_lshlrev_b32 v2, 16, v36
    v_and_b32 v3, s64, v36
    v_pk_add_f32 v[24:25], v[24:25], v[2:3]
    v_lshlrev_b32 v2, 16, v37
    v_and_b32 v3, s64, v37
    v_pk_add_f32 v[26:27], v[26:27], v[2:3]
    s_waitcnt vmcnt(4)
    v_lshlrev_b32 v2, 16, v38
    v_and_b32 v3, s64, v38
    v_pk_add_f32 v[24:25], v[24:25], v[2:3]
    v_lshlrev_b32 v2, 16, v39
    v_and_b32 v3, s64, v39
    v_pk_add_f32 v[26:27], v[26:27], v[2:3]
    s_waitcnt vmcnt(3)
    v_lshlrev_b32 v2, 16, v40
    v_and_b32 v3, s64, v40
    v_pk_add_f32 v[24:25], v[24:25], v[2:3]
    v_lshlrev_b32 v2, 16, v41
    v_and_b32 v3, s64, v41
    v_pk_add_f32 v[26:27], v[26:27], v[2:3]
    s_waitcnt vmcnt(2)
    v_lshlrev_b32 v2, 16, v42
    v_and_b32 v3, s64, v42
    v_pk_add_f32 v[24:25], v[24:25], v[2:3]
    v_lshlrev_b32 v2, 16, v43
    v_and_b32 v3, s64, v43
    v_pk_add_f32 v[26:27], v[26:27], v[2:3]
    s_waitcnt vmcnt(1)
    v_lshlrev_b32 v2, 16, v44
    v_and_b32 v3, s64, v44
    v_pk_add_f32 v[24:25], v[24:25], v[2:3]
    v_lshlrev_b32 v2, 16, v45
    v_and_b32 v3, s64, v45
    v_pk_add_f32 v[26:27], v[26:27], v[2:3]
    s_waitcnt vmcnt(0)
    v_lshlrev_b32 v2, 16, v46
    v_and_b32 v3, s64, v46
    v_pk_add_f32 v[24:25], v[24:25], v[2:3]
    v_lshlrev_b32 v2, 16, v47
    v_and_b32 v3, s64, v47
    v_pk_add_f32 v[26:27], v[26:27], v[2:3]
    v_cvt_pk_bf16_f32 v24, v24, v25
    v_cvt_pk_bf16_f32 v25, v26, v27
    buffer_store_dwordx2 v[24:25], v6, s[52:55], s63 offen offset:0
L_fin:
L_end:
    s_endpgm
L_comp:
    s_memrealtime s[60:61]
    v_and_b32 v1, 31, v0
    v_lshrrev_b32 v2, 5, v0
    v_bfe_u32 v3, v0, 1, 3
    v_xor_b32 v3, v3, v2
    s_lshl_b32 s3, s25, 12
    v_lshl_add_u32 v4, v1, 7, s3

    v_lshrrev_b32 v6, 4, v0
    v_bfe_u32 v3, v0, 1, 3
    v_xor_b32 v3, v3, v6
    v_and_b32 v4, 15, v0
    v_lshl_add_u32 v4, v4, 7, s3
    v_lshl_add_u32 v20, v3, 4, v4
    v_xor_b32 v3, 4, v3
    v_lshl_add_u32 v21, v3, 4, v4
    v_bfe_u32 v3, v0, 2, 2
    v_lshl_add_u32 v4, v6, 3, v3
    v_and_b32 v5, 3, v0
    v_lshlrev_b32 v5, 3, v5
    v_lshl_add_u32 v4, v4, 8, v5
    v_add_u32 v4, 98304, v4
    v_and_b32 v6, 1, v6
    v_lshl_add_u32 v3, v3, 1, v6
    v_xor_b32 v5, 0, v3
    v_lshl_add_u32 v132, v5, 5, v4
    v_xor_b32 v5, 1, v3
    v_lshl_add_u32 v133, v5, 5, v4
    v_xor_b32 v5, 2, v3
    v_lshl_add_u32 v134, v5, 5, v4
    v_xor_b32 v5, 3, v3
    v_lshl_add_u32 v135, v5, 5, v4
    v_xor_b32 v5, 4, v3
    v_lshl_add_u32 v136, v5, 5, v4
    v_xor_b32 v5, 5, v3
    v_lshl_add_u32 v137, v5, 5, v4
    v_xor_b32 v5, 6, v3
    v_lshl_add_u32 v138, v5, 5, v4
    v_xor_b32 v5, 7, v3
    v_lshl_add_u32 v139, v5, 5, v4
    v_and_b32 v3, 15, v0
    v_xor_b32 v3, v3, v2
    v_lshlrev_b32 v4, 8, v1
    v_xor_b32 v5, 0, v3
    v_lshl_add_u32 v8, v5, 4, v4
    v_xor_b32 v5, 2, v3
    v_lshl_add_u32 v9, v5, 4, v4
    v_xor_b32 v5, 4, v3
    v_lshl_add_u32 v10, v5, 4, v4
    v_xor_b32 v5, 6, v3
    v_lshl_add_u32 v11, v5, 4, v4
    v_xor_b32 v5, 8, v3
    v_lshl_add_u32 v12, v5, 4, v4
    v_xor_b32 v5, 10, v3
    v_lshl_add_u32 v13, v5, 4, v4
    v_xor_b32 v5, 12, v3
    v_lshl_add_u32 v14, v5, 4, v4
    v_xor_b32 v5, 14, v3
    v_lshl_add_u32 v15, v5, 4, v4
    v_bfe_u32 v3, v0, 2, 2
    v_bfe_u32 v4, v0, 4, 1
    v_lshlrev_b32 v4, 5, v4
    v_lshl_add_u32 v4, v3, 8, v4
    v_and_b32 v5, 1, v0
    v_lshl_add_u32 v4, v5, 4, v4
    v_bfe_u32 v5, v0, 1, 1
    v_lshl_add_u32 v4, v5, 3, v4
    v_lshl_add_u32 v4, v2, 11, v4
    v_add_u32 v4, 98304, v4
    v_lshlrev_b32 v7, 10, v2

    v_xor_b32 v5, 0, v3
    v_lshl_add_u32 v16, v5, 6, v4
    v_xor_b32 v5, 1, v3
    v_lshl_add_u32 v17, v5, 6, v4
    v_xor_b32 v5, 2, v3
    v_lshl_add_u32 v18, v5, 6, v4
    v_xor_b32 v5, 3, v3
    v_lshl_add_u32 v19, v5, 6, v4
    v_mov_b32 v24, 0
    v_mov_b32 v25, 0
    s_waitcnt lgkmcnt(0)
    s_add_u32 s36, s6, s26
    s_addc_u32 s37, s7, 0
    s_mov_b32 s38, 131072
    s_mov_b32 s39, 0x20000
    s_add_u32 s40, s8, s26
    s_addc_u32 s41, s9, 0
    s_mov_b32 s42, 131072
    s_mov_b32 s43, 0x20000
    s_mov_b32 s48, s18
    s_mov_b32 s49, s19
    s_mov_b32 s50, 67108864
    s_mov_b32 s51, 0x20000
    s_mov_b32 s56, s16
    s_mov_b32 s57, s17
    s_mov_b32 s58, 256
    s_mov_b32 s59, 0x20000
    s_lshl_b32 s93, s27, 7
    s_add_u32 s93, s93, 35651584
    s_mov_b32 s62, 0x3e0293ee
    s_mov_b32 s63, 0x3f803f80
    s_andn2_b32 s60, s60, 15
    s_or_b32 s60, s60, 16
    v_mov_b32 v4, s60
    v_mov_b32 v5, s61
    s_or_b32 s3, s20, s22
    s_cbranch_scc1 L_noatom
    s_mov_b64 exec, 1
    buffer_store_dwordx2 v[4:5], off, s[56:59], s92 sc1
    s_mov_b64 exec, -1
L_noatom:

    s_barrier
    ds_read_b128 v[116:119], v20 offset:0
    ds_read_b128 v[120:123], v20 offset:2048
    ds_read_b64_tr_b16 v[28:29], v132 offset:32768
    ds_read_b64_tr_b16 v[30:31], v132 offset:33792
    ds_read_b128 v[124:127], v21 offset:0
    ds_read_b128 v[128:131], v21 offset:2048
    ds_read_b64_tr_b16 v[32:33], v132 offset:40960
    ds_read_b64_tr_b16 v[34:35], v132 offset:41984
    ds_read_b64_tr_b16 v[36:37], v133 offset:32768
    ds_read_b64_tr_b16 v[38:39], v133 offset:33792
    ds_read_b64_tr_b16 v[40:41], v133 offset:40960
    ds_read_b64_tr_b16 v[42:43], v133 offset:41984
    ds_read_b64_tr_b16 v[44:45], v134 offset:32768
    ds_read_b64_tr_b16 v[46:47], v134 offset:33792
    s_waitcnt lgkmcnt(6)
    v_mfma_f32_16x16x32_bf16 v[148:151], v[28:31], v[116:119], 0
    ds_read_b64_tr_b16 v[48:49], v134 offset:40960
    v_mfma_f32_16x16x32_bf16 v[152:155], v[28:31], v[120:123], 0
    ds_read_b64_tr_b16 v[50:51], v134 offset:41984
    v_mfma_f32_16x16x32_bf16 v[148:151], v[32:35], v[124:127], v[148:151]
    ds_read_b64_tr_b16 v[28:29], v135 offset:32768
    v_mfma_f32_16x16x32_bf16 v[152:155], v[32:35], v[128:131], v[152:155]
    ds_read_b64_tr_b16 v[30:31], v135 offset:33792
    s_waitcnt lgkmcnt(6)
    v_mfma_f32_16x16x32_bf16 v[156:159], v[36:39], v[116:119], 0
    ds_read_b64_tr_b16 v[32:33], v135 offset:40960
    v_mfma_f32_16x16x32_bf16 v[160:163], v[36:39], v[120:123], 0
    ds_read_b64_tr_b16 v[34:35], v135 offset:41984
    v_mfma_f32_16x16x32_bf16 v[156:159], v[40:43], v[124:127], v[156:159]
    ds_read_b64_tr_b16 v[36:37], v136 offset:32768
    v_mfma_f32_16x16x32_bf16 v[160:163], v[40:43], v[128:131], v[160:163]
    ds_read_b64_tr_b16 v[38:39], v136 offset:33792
    s_waitcnt lgkmcnt(6)
    v_mfma_f32_16x16x32_bf16 v[164:167], v[44:47], v[116:119], 0
    ds_read_b64_tr_b16 v[40:41], v136 offset:40960
    v_mfma_f32_16x16x32_bf16 v[168:171], v[44:47], v[120:123], 0
    ds_read_b64_tr_b16 v[42:43], v136 offset:41984
    v_mfma_f32_16x16x32_bf16 v[164:167], v[48:51], v[124:127], v[164:167]
    ds_read_b64_tr_b16 v[44:45], v137 offset:32768
    v_mfma_f32_16x16x32_bf16 v[168:171], v[48:51], v[128:131], v[168:171]
    ds_read_b64_tr_b16 v[46:47], v137 offset:33792
    s_waitcnt lgkmcnt(6)
    v_mfma_f32_16x16x32_bf16 v[172:175], v[28:31], v[116:119], 0
    ds_read_b64_tr_b16 v[48:49], v137 offset:40960
    v_mfma_f32_16x16x32_bf16 v[176:179], v[28:31], v[120:123], 0
    ds_read_b64_tr_b16 v[50:51], v137 offset:41984
    v_mfma_f32_16x16x32_bf16 v[172:175], v[32:35], v[124:127], v[172:175]
    ds_read_b64_tr_b16 v[28:29], v138 offset:32768
    v_mfma_f32_16x16x32_bf16 v[176:179], v[32:35], v[128:131], v[176:179]
    ds_read_b64_tr_b16 v[30:31], v138 offset:33792
    s_waitcnt lgkmcnt(6)
    v_mfma_f32_16x16x32_bf16 v[180:183], v[36:39], v[116:119], 0
    ds_read_b64_tr_b16 v[32:33], v138 offset:40960
    v_mfma_f32_16x16x32_bf16 v[184:187], v[36:39], v[120:123], 0
    ds_read_b64_tr_b16 v[34:35], v138 offset:41984
    v_mfma_f32_16x16x32_bf16 v[180:183], v[40:43], v[124:127], v[180:183]
    ds_read_b64_tr_b16 v[36:37], v139 offset:32768
    v_mfma_f32_16x16x32_bf16 v[184:187], v[40:43], v[128:131], v[184:187]
    ds_read_b64_tr_b16 v[38:39], v139 offset:33792
    s_waitcnt lgkmcnt(6)
    v_mfma_f32_16x16x32_bf16 v[188:191], v[44:47], v[116:119], 0
    ds_read_b64_tr_b16 v[40:41], v139 offset:40960
    v_mfma_f32_16x16x32_bf16 v[192:195], v[44:47], v[120:123], 0
    ds_read_b64_tr_b16 v[42:43], v139 offset:41984
    v_mfma_f32_16x16x32_bf16 v[188:191], v[48:51], v[124:127], v[188:191]
    s_barrier
    ds_read_b128 v[84:87], v20 offset:49152
    ds_read_b128 v[88:91], v20 offset:51200
    v_mfma_f32_16x16x32_bf16 v[192:195], v[48:51], v[128:131], v[192:195]
    ds_read_b64_tr_b16 v[44:45], v132 offset:49152
    ds_read_b64_tr_b16 v[46:47], v132 offset:50176
    s_waitcnt lgkmcnt(8)
    v_mfma_f32_16x16x32_bf16 v[196:199], v[28:31], v[116:119], 0
    ds_read_b128 v[92:95], v21 offset:49152
    ds_read_b128 v[96:99], v21 offset:51200
    v_mfma_f32_16x16x32_bf16 v[200:203], v[28:31], v[120:123], 0
    ds_read_b64_tr_b16 v[48:49], v132 offset:57344
    ds_read_b64_tr_b16 v[50:51], v132 offset:58368
    v_mfma_f32_16x16x32_bf16 v[196:199], v[32:35], v[124:127], v[196:199]
    ds_read_b64_tr_b16 v[28:29], v133 offset:49152
    v_mfma_f32_16x16x32_bf16 v[200:203], v[32:35], v[128:131], v[200:203]
    ds_read_b64_tr_b16 v[30:31], v133 offset:50176
    s_waitcnt lgkmcnt(10)
    v_mfma_f32_16x16x32_bf16 v[204:207], v[36:39], v[116:119], 0
    ds_read_b64_tr_b16 v[32:33], v133 offset:57344
    v_mfma_f32_16x16x32_bf16 v[208:211], v[36:39], v[120:123], 0
    ds_read_b64_tr_b16 v[34:35], v133 offset:58368
    v_mfma_f32_16x16x32_bf16 v[204:207], v[40:43], v[124:127], v[204:207]
    ds_read_b64_tr_b16 v[36:37], v134 offset:49152
    v_mfma_f32_16x16x32_bf16 v[208:211], v[40:43], v[128:131], v[208:211]
    ds_read_b64_tr_b16 v[38:39], v134 offset:50176
    s_waitcnt lgkmcnt(6)
    v_mfma_f32_16x16x32_bf16 v[148:151], v[44:47], v[84:87], v[148:151]
    ds_read_b64_tr_b16 v[40:41], v134 offset:57344
    v_mfma_f32_16x16x32_bf16 v[152:155], v[44:47], v[88:91], v[152:155]
    ds_read_b64_tr_b16 v[42:43], v134 offset:58368
    v_mfma_f32_16x16x32_bf16 v[148:151], v[48:51], v[92:95], v[148:151]
    ds_read_b64_tr_b16 v[44:45], v135 offset:49152
    v_mfma_f32_16x16x32_bf16 v[152:155], v[48:51], v[96:99], v[152:155]
    ds_read_b64_tr_b16 v[46:47], v135 offset:50176
    s_waitcnt lgkmcnt(6)
    v_mfma_f32_16x16x32_bf16 v[156:159], v[28:31], v[84:87], v[156:159]
    ds_read_b64_tr_b16 v[48:49], v135 offset:57344
    v_mfma_f32_16x16x32_bf16 v[160:163], v[28:31], v[88:91], v[160:163]
    ds_read_b64_tr_b16 v[50:51], v135 offset:58368
    v_mfma_f32_16x16x32_bf16 v[156:159], v[32:35], v[92:95], v[156:159]
    ds_read_b64_tr_b16 v[28:29], v136 offset:49152
    v_mfma_f32_16x16x32_bf16 v[160:163], v[32:35], v[96:99], v[160:163]
    ds_read_b64_tr_b16 v[30:31], v136 offset:50176
    s_waitcnt lgkmcnt(6)
    v_mfma_f32_16x16x32_bf16 v[164:167], v[36:39], v[84:87], v[164:167]
    ds_read_b64_tr_b16 v[32:33], v136 offset:57344
    v_mfma_f32_16x16x32_bf16 v[168:171], v[36:39], v[88:91], v[168:171]
    ds_read_b64_tr_b16 v[34:35], v136 offset:58368
    v_mfma_f32_16x16x32_bf16 v[164:167], v[40:43], v[92:95], v[164:167]
    ds_read_b64_tr_b16 v[36:37], v137 offset:49152
    v_mfma_f32_16x16x32_bf16 v[168:171], v[40:43], v[96:99], v[168:171]
    ds_read_b64_tr_b16 v[38:39], v137 offset:50176
    s_waitcnt lgkmcnt(6)
    v_mfma_f32_16x16x32_bf16 v[172:175], v[44:47], v[84:87], v[172:175]
    ds_read_b64_tr_b16 v[40:41], v137 offset:57344
    v_mfma_f32_16x16x32_bf16 v[176:179], v[44:47], v[88:91], v[176:179]
    ds_read_b64_tr_b16 v[42:43], v137 offset:58368
    v_mfma_f32_16x16x32_bf16 v[172:175], v[48:51], v[92:95], v[172:175]
    ds_read_b64_tr_b16 v[44:45], v138 offset:49152
    v_mfma_f32_16x16x32_bf16 v[176:179], v[48:51], v[96:99], v[176:179]
    ds_read_b64_tr_b16 v[46:47], v138 offset:50176
    s_waitcnt lgkmcnt(6)
    v_mfma_f32_16x16x32_bf16 v[180:183], v[28:31], v[84:87], v[180:183]
    ds_read_b64_tr_b16 v[48:49], v138 offset:57344
    v_mfma_f32_16x16x32_bf16 v[184:187], v[28:31], v[88:91], v[184:187]
    ds_read_b64_tr_b16 v[50:51], v138 offset:58368
    v_mfma_f32_16x16x32_bf16 v[180:183], v[32:35], v[92:95], v[180:183]
    ds_read_b64_tr_b16 v[28:29], v139 offset:49152
    v_mfma_f32_16x16x32_bf16 v[184:187], v[32:35], v[96:99], v[184:187]
    ds_read_b64_tr_b16 v[30:31], v139 offset:50176
    s_waitcnt lgkmcnt(6)
    v_mfma_f32_16x16x32_bf16 v[188:191], v[36:39], v[84:87], v[188:191]
    ds_read_b64_tr_b16 v[32:33], v139 offset:57344
    v_mfma_f32_16x16x32_bf16 v[192:195], v[36:39], v[88:91], v[192:195]
    ds_read_b64_tr_b16 v[34:35], v139 offset:58368
    v_mfma_f32_16x16x32_bf16 v[188:191], v[40:43], v[92:95], v[188:191]
    s_barrier
    ds_read_b128 v[116:119], v20 offset:32768
    ds_read_b128 v[120:123], v20 offset:34816
    v_mfma_f32_16x16x32_bf16 v[192:195], v[40:43], v[96:99], v[192:195]
    ds_read_b64_tr_b16 v[36:37], v132 offset:0
    ds_read_b64_tr_b16 v[38:39], v132 offset:1024
    s_waitcnt lgkmcnt(8)
    v_mfma_f32_16x16x32_bf16 v[196:199], v[44:47], v[84:87], v[196:199]
    ds_read_b128 v[124:127], v21 offset:32768
    ds_read_b128 v[128:131], v21 offset:34816
    v_mfma_f32_16x16x32_bf16 v[200:203], v[44:47], v[88:91], v[200:203]
    ds_read_b64_tr_b16 v[40:41], v132 offset:8192
    ds_read_b64_tr_b16 v[42:43], v132 offset:9216
    v_mfma_f32_16x16x32_bf16 v[196:199], v[48:51], v[92:95], v[196:199]
    ds_read_b64_tr_b16 v[44:45], v133 offset:0
    v_mfma_f32_16x16x32_bf16 v[200:203], v[48:51], v[96:99], v[200:203]
    ds_read_b64_tr_b16 v[46:47], v133 offset:1024
    s_waitcnt lgkmcnt(10)
    v_mfma_f32_16x16x32_bf16 v[204:207], v[28:31], v[84:87], v[204:207]
    ds_read_b64_tr_b16 v[48:49], v133 offset:8192
    v_mfma_f32_16x16x32_bf16 v[208:211], v[28:31], v[88:91], v[208:211]
    ds_read_b64_tr_b16 v[50:51], v133 offset:9216
    v_mfma_f32_16x16x32_bf16 v[204:207], v[32:35], v[92:95], v[204:207]
    ds_read_b64_tr_b16 v[28:29], v134 offset:0
    v_mfma_f32_16x16x32_bf16 v[208:211], v[32:35], v[96:99], v[208:211]
    ds_read_b64_tr_b16 v[30:31], v134 offset:1024
    s_waitcnt lgkmcnt(6)
    v_mfma_f32_16x16x32_bf16 v[148:151], v[36:39], v[116:119], v[148:151]
    ds_read_b64_tr_b16 v[32:33], v134 offset:8192
    v_mfma_f32_16x16x32_bf16 v[152:155], v[36:39], v[120:123], v[152:155]
    ds_read_b64_tr_b16 v[34:35], v134 offset:9216
    v_mfma_f32_16x16x32_bf16 v[148:151], v[40:43], v[124:127], v[148:151]
    ds_read_b64_tr_b16 v[36:37], v135 offset:0
    v_mfma_f32_16x16x32_bf16 v[152:155], v[40:43], v[128:131], v[152:155]
    ds_read_b64_tr_b16 v[38:39], v135 offset:1024
    s_waitcnt lgkmcnt(6)
    v_mfma_f32_16x16x32_bf16 v[156:159], v[44:47], v[116:119], v[156:159]
    ds_read_b64_tr_b16 v[40:41], v135 offset:8192
    v_mfma_f32_16x16x32_bf16 v[160:163], v[44:47], v[120:123], v[160:163]
    ds_read_b64_tr_b16 v[42:43], v135 offset:9216
    v_mfma_f32_16x16x32_bf16 v[156:159], v[48:51], v[124:127], v[156:159]
    ds_read_b64_tr_b16 v[44:45], v136 offset:0
    v_mfma_f32_16x16x32_bf16 v[160:163], v[48:51], v[128:131], v[160:163]
    ds_read_b64_tr_b16 v[46:47], v136 offset:1024
    s_waitcnt lgkmcnt(6)
    v_mfma_f32_16x16x32_bf16 v[164:167], v[28:31], v[116:119], v[164:167]
    ds_read_b64_tr_b16 v[48:49], v136 offset:8192
    v_mfma_f32_16x16x32_bf16 v[168:171], v[28:31], v[120:123], v[168:171]
    ds_read_b64_tr_b16 v[50:51], v136 offset:9216
    v_mfma_f32_16x16x32_bf16 v[164:167], v[32:35], v[124:127], v[164:167]
    ds_read_b64_tr_b16 v[28:29], v137 offset:0
    v_mfma_f32_16x16x32_bf16 v[168:171], v[32:35], v[128:131], v[168:171]
    ds_read_b64_tr_b16 v[30:31], v137 offset:1024
    s_waitcnt lgkmcnt(6)
    v_mfma_f32_16x16x32_bf16 v[172:175], v[36:39], v[116:119], v[172:175]
    ds_read_b64_tr_b16 v[32:33], v137 offset:8192
    v_mfma_f32_16x16x32_bf16 v[176:179], v[36:39], v[120:123], v[176:179]
    ds_read_b64_tr_b16 v[34:35], v137 offset:9216
    v_mfma_f32_16x16x32_bf16 v[172:175], v[40:43], v[124:127], v[172:175]
    ds_read_b64_tr_b16 v[36:37], v138 offset:0
    v_mfma_f32_16x16x32_bf16 v[176:179], v[40:43], v[128:131], v[176:179]
    ds_read_b64_tr_b16 v[38:39], v138 offset:1024
    s_waitcnt lgkmcnt(6)
    v_mfma_f32_16x16x32_bf16 v[180:183], v[44:47], v[116:119], v[180:183]
    ds_read_b64_tr_b16 v[40:41], v138 offset:8192
    v_mfma_f32_16x16x32_bf16 v[184:187], v[44:47], v[120:123], v[184:187]
    ds_read_b64_tr_b16 v[42:43], v138 offset:9216
    v_mfma_f32_16x16x32_bf16 v[180:183], v[48:51], v[124:127], v[180:183]
    ds_read_b64_tr_b16 v[44:45], v139 offset:0
    v_mfma_f32_16x16x32_bf16 v[184:187], v[48:51], v[128:131], v[184:187]
    ds_read_b64_tr_b16 v[46:47], v139 offset:1024
    s_waitcnt lgkmcnt(6)
    v_mfma_f32_16x16x32_bf16 v[188:191], v[28:31], v[116:119], v[188:191]
    ds_read_b64_tr_b16 v[48:49], v139 offset:8192
    v_mfma_f32_16x16x32_bf16 v[192:195], v[28:31], v[120:123], v[192:195]
    ds_read_b64_tr_b16 v[50:51], v139 offset:9216
    v_mfma_f32_16x16x32_bf16 v[188:191], v[32:35], v[124:127], v[188:191]
    s_barrier
    ds_read_b128 v[84:87], v20 offset:16384
    ds_read_b128 v[88:91], v20 offset:18432
    v_mfma_f32_16x16x32_bf16 v[192:195], v[32:35], v[128:131], v[192:195]
    ds_read_b64_tr_b16 v[28:29], v132 offset:16384
    ds_read_b64_tr_b16 v[30:31], v132 offset:17408
    s_waitcnt lgkmcnt(8)
    v_mfma_f32_16x16x32_bf16 v[196:199], v[36:39], v[116:119], v[196:199]
    ds_read_b128 v[92:95], v21 offset:16384
    ds_read_b128 v[96:99], v21 offset:18432
    v_mfma_f32_16x16x32_bf16 v[200:203], v[36:39], v[120:123], v[200:203]
    ds_read_b64_tr_b16 v[32:33], v132 offset:24576
    ds_read_b64_tr_b16 v[34:35], v132 offset:25600
    v_mfma_f32_16x16x32_bf16 v[196:199], v[40:43], v[124:127], v[196:199]
    ds_read_b64_tr_b16 v[36:37], v133 offset:16384
    v_mfma_f32_16x16x32_bf16 v[200:203], v[40:43], v[128:131], v[200:203]
    ds_read_b64_tr_b16 v[38:39], v133 offset:17408
    s_waitcnt lgkmcnt(10)
    v_mfma_f32_16x16x32_bf16 v[204:207], v[44:47], v[116:119], v[204:207]
    ds_read_b64_tr_b16 v[40:41], v133 offset:24576
    v_mfma_f32_16x16x32_bf16 v[208:211], v[44:47], v[120:123], v[208:211]
    ds_read_b64_tr_b16 v[42:43], v133 offset:25600
    v_mfma_f32_16x16x32_bf16 v[204:207], v[48:51], v[124:127], v[204:207]
    ds_read_b64_tr_b16 v[44:45], v134 offset:16384
    v_mfma_f32_16x16x32_bf16 v[208:211], v[48:51], v[128:131], v[208:211]
    ds_read_b64_tr_b16 v[46:47], v134 offset:17408
    s_waitcnt lgkmcnt(6)
    v_mfma_f32_16x16x32_bf16 v[148:151], v[28:31], v[84:87], v[148:151]
    ds_read_b64_tr_b16 v[48:49], v134 offset:24576
    v_mfma_f32_16x16x32_bf16 v[152:155], v[28:31], v[88:91], v[152:155]
    ds_read_b64_tr_b16 v[50:51], v134 offset:25600
    v_mfma_f32_16x16x32_bf16 v[148:151], v[32:35], v[92:95], v[148:151]
    ds_read_b64_tr_b16 v[28:29], v135 offset:16384
    v_mfma_f32_16x16x32_bf16 v[152:155], v[32:35], v[96:99], v[152:155]
    ds_read_b64_tr_b16 v[30:31], v135 offset:17408
    s_waitcnt lgkmcnt(6)
    v_mfma_f32_16x16x32_bf16 v[156:159], v[36:39], v[84:87], v[156:159]
    ds_read_b64_tr_b16 v[32:33], v135 offset:24576
    v_mfma_f32_16x16x32_bf16 v[160:163], v[36:39], v[88:91], v[160:163]
    ds_read_b64_tr_b16 v[34:35], v135 offset:25600
    v_mfma_f32_16x16x32_bf16 v[156:159], v[40:43], v[92:95], v[156:159]
    ds_read_b64_tr_b16 v[36:37], v136 offset:16384
    v_mfma_f32_16x16x32_bf16 v[160:163], v[40:43], v[96:99], v[160:163]
    ds_read_b64_tr_b16 v[38:39], v136 offset:17408
    s_waitcnt lgkmcnt(6)
    v_mfma_f32_16x16x32_bf16 v[164:167], v[44:47], v[84:87], v[164:167]
    ds_read_b64_tr_b16 v[40:41], v136 offset:24576
    v_mfma_f32_16x16x32_bf16 v[168:171], v[44:47], v[88:91], v[168:171]
    ds_read_b64_tr_b16 v[42:43], v136 offset:25600
    v_mfma_f32_16x16x32_bf16 v[164:167], v[48:51], v[92:95], v[164:167]
    ds_read_b64_tr_b16 v[44:45], v137 offset:16384
    v_mfma_f32_16x16x32_bf16 v[168:171], v[48:51], v[96:99], v[168:171]
    ds_read_b64_tr_b16 v[46:47], v137 offset:17408
    s_waitcnt lgkmcnt(6)
    v_mfma_f32_16x16x32_bf16 v[172:175], v[28:31], v[84:87], v[172:175]
    ds_read_b64_tr_b16 v[48:49], v137 offset:24576
    v_mfma_f32_16x16x32_bf16 v[176:179], v[28:31], v[88:91], v[176:179]
    ds_read_b64_tr_b16 v[50:51], v137 offset:25600
    v_mfma_f32_16x16x32_bf16 v[172:175], v[32:35], v[92:95], v[172:175]
    ds_read_b64_tr_b16 v[28:29], v138 offset:16384
    v_mfma_f32_16x16x32_bf16 v[176:179], v[32:35], v[96:99], v[176:179]
    ds_read_b64_tr_b16 v[30:31], v138 offset:17408
    s_waitcnt lgkmcnt(6)
    v_mfma_f32_16x16x32_bf16 v[180:183], v[36:39], v[84:87], v[180:183]
    ds_read_b64_tr_b16 v[32:33], v138 offset:24576
    v_mfma_f32_16x16x32_bf16 v[184:187], v[36:39], v[88:91], v[184:187]
    ds_read_b64_tr_b16 v[34:35], v138 offset:25600
    v_mfma_f32_16x16x32_bf16 v[180:183], v[40:43], v[92:95], v[180:183]
    ds_read_b64_tr_b16 v[36:37], v139 offset:16384
    v_mfma_f32_16x16x32_bf16 v[184:187], v[40:43], v[96:99], v[184:187]
    ds_read_b64_tr_b16 v[38:39], v139 offset:17408
    s_waitcnt lgkmcnt(6)
    v_mfma_f32_16x16x32_bf16 v[188:191], v[44:47], v[84:87], v[188:191]
    ds_read_b64_tr_b16 v[40:41], v139 offset:24576
    v_mfma_f32_16x16x32_bf16 v[192:195], v[44:47], v[88:91], v[192:195]
    ds_read_b64_tr_b16 v[42:43], v139 offset:25600
    v_mfma_f32_16x16x32_bf16 v[188:191], v[48:51], v[92:95], v[188:191]
    s_barrier
    ds_read_b128 v[116:119], v20 offset:0
    ds_read_b128 v[120:123], v20 offset:2048
    v_mfma_f32_16x16x32_bf16 v[192:195], v[48:51], v[96:99], v[192:195]
    ds_read_b64_tr_b16 v[44:45], v132 offset:32768
    ds_read_b64_tr_b16 v[46:47], v132 offset:33792
    s_waitcnt lgkmcnt(8)
    v_mfma_f32_16x16x32_bf16 v[196:199], v[28:31], v[84:87], v[196:199]
    ds_read_b128 v[124:127], v21 offset:0
    ds_read_b128 v[128:131], v21 offset:2048
    v_mfma_f32_16x16x32_bf16 v[200:203], v[28:31], v[88:91], v[200:203]
    ds_read_b64_tr_b16 v[48:49], v132 offset:40960
    ds_read_b64_tr_b16 v[50:51], v132 offset:41984
    v_mfma_f32_16x16x32_bf16 v[196:199], v[32:35], v[92:95], v[196:199]
    ds_read_b64_tr_b16 v[28:29], v133 offset:32768
    v_mfma_f32_16x16x32_bf16 v[200:203], v[32:35], v[96:99], v[200:203]
    ds_read_b64_tr_b16 v[30:31], v133 offset:33792
    s_waitcnt lgkmcnt(10)
    v_mfma_f32_16x16x32_bf16 v[204:207], v[36:39], v[84:87], v[204:207]
    ds_read_b64_tr_b16 v[32:33], v133 offset:40960
    v_mfma_f32_16x16x32_bf16 v[208:211], v[36:39], v[88:91], v[208:211]
    ds_read_b64_tr_b16 v[34:35], v133 offset:41984
    v_mfma_f32_16x16x32_bf16 v[204:207], v[40:43], v[92:95], v[204:207]
    ds_read_b64_tr_b16 v[36:37], v134 offset:32768
    v_mfma_f32_16x16x32_bf16 v[208:211], v[40:43], v[96:99], v[208:211]
    ds_read_b64_tr_b16 v[38:39], v134 offset:33792
    s_waitcnt lgkmcnt(6)
    v_mfma_f32_16x16x32_bf16 v[148:151], v[44:47], v[116:119], v[148:151]
    ds_read_b64_tr_b16 v[40:41], v134 offset:40960
    v_mfma_f32_16x16x32_bf16 v[152:155], v[44:47], v[120:123], v[152:155]
    ds_read_b64_tr_b16 v[42:43], v134 offset:41984
    v_mfma_f32_16x16x32_bf16 v[148:151], v[48:51], v[124:127], v[148:151]
    ds_read_b64_tr_b16 v[44:45], v135 offset:32768
    v_mfma_f32_16x16x32_bf16 v[152:155], v[48:51], v[128:131], v[152:155]
    ds_read_b64_tr_b16 v[46:47], v135 offset:33792
    s_waitcnt lgkmcnt(6)
    v_mfma_f32_16x16x32_bf16 v[156:159], v[28:31], v[116:119], v[156:159]
    ds_read_b64_tr_b16 v[48:49], v135 offset:40960
    v_mfma_f32_16x16x32_bf16 v[160:163], v[28:31], v[120:123], v[160:163]
    ds_read_b64_tr_b16 v[50:51], v135 offset:41984
    v_mfma_f32_16x16x32_bf16 v[156:159], v[32:35], v[124:127], v[156:159]
    ds_read_b64_tr_b16 v[28:29], v136 offset:32768
    v_mfma_f32_16x16x32_bf16 v[160:163], v[32:35], v[128:131], v[160:163]
    ds_read_b64_tr_b16 v[30:31], v136 offset:33792
    s_waitcnt lgkmcnt(6)
    v_mfma_f32_16x16x32_bf16 v[164:167], v[36:39], v[116:119], v[164:167]
    ds_read_b64_tr_b16 v[32:33], v136 offset:40960
    v_mfma_f32_16x16x32_bf16 v[168:171], v[36:39], v[120:123], v[168:171]
    ds_read_b64_tr_b16 v[34:35], v136 offset:41984
    v_mfma_f32_16x16x32_bf16 v[164:167], v[40:43], v[124:127], v[164:167]
    ds_read_b64_tr_b16 v[36:37], v137 offset:32768
    v_mfma_f32_16x16x32_bf16 v[168:171], v[40:43], v[128:131], v[168:171]
L_t3:
    s_cmp_eq_u32 s100, 1
    s_cbranch_scc1 L_t6
    ds_read_b64_tr_b16 v[38:39], v137 offset:33792
    s_waitcnt lgkmcnt(6)
    v_mfma_f32_16x16x32_bf16 v[172:175], v[44:47], v[116:119], v[172:175]
    ds_read_b64_tr_b16 v[40:41], v137 offset:40960
    v_mfma_f32_16x16x32_bf16 v[176:179], v[44:47], v[120:123], v[176:179]
    ds_read_b64_tr_b16 v[42:43], v137 offset:41984
    v_mfma_f32_16x16x32_bf16 v[172:175], v[48:51], v[124:127], v[172:175]
    ds_read_b64_tr_b16 v[44:45], v138 offset:32768
    v_mfma_f32_16x16x32_bf16 v[176:179], v[48:51], v[128:131], v[176:179]
    ds_read_b64_tr_b16 v[46:47], v138 offset:33792
    s_waitcnt lgkmcnt(6)
    v_mfma_f32_16x16x32_bf16 v[180:183], v[28:31], v[116:119], v[180:183]
    ds_read_b64_tr_b16 v[48:49], v138 offset:40960
    v_mfma_f32_16x16x32_bf16 v[184:187], v[28:31], v[120:123], v[184:187]
    ds_read_b64_tr_b16 v[50:51], v138 offset:41984
    v_mfma_f32_16x16x32_bf16 v[180:183], v[32:35], v[124:127], v[180:183]
    ds_read_b64_tr_b16 v[28:29], v139 offset:32768
    v_mfma_f32_16x16x32_bf16 v[184:187], v[32:35], v[128:131], v[184:187]
    ds_read_b64_tr_b16 v[30:31], v139 offset:33792
    s_waitcnt lgkmcnt(6)
    v_mfma_f32_16x16x32_bf16 v[188:191], v[36:39], v[116:119], v[188:191]
    ds_read_b64_tr_b16 v[32:33], v139 offset:40960
    v_mfma_f32_16x16x32_bf16 v[192:195], v[36:39], v[120:123], v[192:195]
    ds_read_b64_tr_b16 v[34:35], v139 offset:41984
    v_mfma_f32_16x16x32_bf16 v[188:191], v[40:43], v[124:127], v[188:191]
    s_barrier
    ds_read_b128 v[84:87], v20 offset:49152
    ds_read_b128 v[88:91], v20 offset:51200
    v_mfma_f32_16x16x32_bf16 v[192:195], v[40:43], v[128:131], v[192:195]
    ds_read_b64_tr_b16 v[36:37], v132 offset:49152
    ds_read_b64_tr_b16 v[38:39], v132 offset:50176
    s_waitcnt lgkmcnt(8)
    v_mfma_f32_16x16x32_bf16 v[196:199], v[44:47], v[116:119], v[196:199]
    ds_read_b128 v[92:95], v21 offset:49152
    ds_read_b128 v[96:99], v21 offset:51200
    v_mfma_f32_16x16x32_bf16 v[200:203], v[44:47], v[120:123], v[200:203]
    ds_read_b64_tr_b16 v[40:41], v132 offset:57344
    ds_read_b64_tr_b16 v[42:43], v132 offset:58368
    v_mfma_f32_16x16x32_bf16 v[196:199], v[48:51], v[124:127], v[196:199]
    ds_read_b64_tr_b16 v[44:45], v133 offset:49152
    v_mfma_f32_16x16x32_bf16 v[200:203], v[48:51], v[128:131], v[200:203]
    ds_read_b64_tr_b16 v[46:47], v133 offset:50176
    s_waitcnt lgkmcnt(10)
    v_mfma_f32_16x16x32_bf16 v[204:207], v[28:31], v[116:119], v[204:207]
    ds_read_b64_tr_b16 v[48:49], v133 offset:57344
    v_mfma_f32_16x16x32_bf16 v[208:211], v[28:31], v[120:123], v[208:211]
    ds_read_b64_tr_b16 v[50:51], v133 offset:58368
    v_mfma_f32_16x16x32_bf16 v[204:207], v[32:35], v[124:127], v[204:207]
    ds_read_b64_tr_b16 v[28:29], v134 offset:49152
    v_mfma_f32_16x16x32_bf16 v[208:211], v[32:35], v[128:131], v[208:211]
    ds_read_b64_tr_b16 v[30:31], v134 offset:50176
    s_waitcnt lgkmcnt(6)
    v_mfma_f32_16x16x32_bf16 v[148:151], v[36:39], v[84:87], v[148:151]
    ds_read_b64_tr_b16 v[32:33], v134 offset:57344
    v_mfma_f32_16x16x32_bf16 v[152:155], v[36:39], v[88:91], v[152:155]
    ds_read_b64_tr_b16 v[34:35], v134 offset:58368
    v_mfma_f32_16x16x32_bf16 v[148:151], v[40:43], v[92:95], v[148:151]
    ds_read_b64_tr_b16 v[36:37], v135 offset:49152
    v_mfma_f32_16x16x32_bf16 v[152:155], v[40:43], v[96:99], v[152:155]
    ds_read_b64_tr_b16 v[38:39], v135 offset:50176
    s_waitcnt lgkmcnt(6)
    v_mfma_f32_16x16x32_bf16 v[156:159], v[44:47], v[84:87], v[156:159]
    ds_read_b64_tr_b16 v[40:41], v135 offset:57344
    v_mfma_f32_16x16x32_bf16 v[160:163], v[44:47], v[88:91], v[160:163]
    ds_read_b64_tr_b16 v[42:43], v135 offset:58368
    v_mfma_f32_16x16x32_bf16 v[156:159], v[48:51], v[92:95], v[156:159]
    ds_read_b64_tr_b16 v[44:45], v136 offset:49152
    v_mfma_f32_16x16x32_bf16 v[160:163], v[48:51], v[96:99], v[160:163]
    ds_read_b64_tr_b16 v[46:47], v136 offset:50176
    s_waitcnt lgkmcnt(6)
    v_mfma_f32_16x16x32_bf16 v[164:167], v[28:31], v[84:87], v[164:167]
    ds_read_b64_tr_b16 v[48:49], v136 offset:57344
    v_mfma_f32_16x16x32_bf16 v[168:171], v[28:31], v[88:91], v[168:171]
    ds_read_b64_tr_b16 v[50:51], v136 offset:58368
    v_mfma_f32_16x16x32_bf16 v[164:167], v[32:35], v[92:95], v[164:167]
    ds_read_b64_tr_b16 v[28:29], v137 offset:49152
    v_mfma_f32_16x16x32_bf16 v[168:171], v[32:35], v[96:99], v[168:171]
    ds_read_b64_tr_b16 v[30:31], v137 offset:50176
    s_waitcnt lgkmcnt(6)
    v_mfma_f32_16x16x32_bf16 v[172:175], v[36:39], v[84:87], v[172:175]
    ds_read_b64_tr_b16 v[32:33], v137 offset:57344
    v_mfma_f32_16x16x32_bf16 v[176:179], v[36:39], v[88:91], v[176:179]
    ds_read_b64_tr_b16 v[34:35], v137 offset:58368
    v_mfma_f32_16x16x32_bf16 v[172:175], v[40:43], v[92:95], v[172:175]
    ds_read_b64_tr_b16 v[36:37], v138 offset:49152
    v_mfma_f32_16x16x32_bf16 v[176:179], v[40:43], v[96:99], v[176:179]
    ds_read_b64_tr_b16 v[38:39], v138 offset:50176
    s_waitcnt lgkmcnt(6)
    v_mfma_f32_16x16x32_bf16 v[180:183], v[44:47], v[84:87], v[180:183]
    ds_read_b64_tr_b16 v[40:41], v138 offset:57344
    v_mfma_f32_16x16x32_bf16 v[184:187], v[44:47], v[88:91], v[184:187]
    ds_read_b64_tr_b16 v[42:43], v138 offset:58368
    v_mfma_f32_16x16x32_bf16 v[180:183], v[48:51], v[92:95], v[180:183]
    ds_read_b64_tr_b16 v[44:45], v139 offset:49152
    v_mfma_f32_16x16x32_bf16 v[184:187], v[48:51], v[96:99], v[184:187]
    ds_read_b64_tr_b16 v[46:47], v139 offset:50176
    s_waitcnt lgkmcnt(6)
    v_mfma_f32_16x16x32_bf16 v[188:191], v[28:31], v[84:87], v[188:191]
    ds_read_b64_tr_b16 v[48:49], v139 offset:57344
    v_mfma_f32_16x16x32_bf16 v[192:195], v[28:31], v[88:91], v[192:195]
    ds_read_b64_tr_b16 v[50:51], v139 offset:58368
    v_mfma_f32_16x16x32_bf16 v[188:191], v[32:35], v[92:95], v[188:191]
    s_barrier
    ds_read_b128 v[116:119], v20 offset:32768
    ds_read_b128 v[120:123], v20 offset:34816
    v_mfma_f32_16x16x32_bf16 v[192:195], v[32:35], v[96:99], v[192:195]
    ds_read_b64_tr_b16 v[28:29], v132 offset:0
    ds_read_b64_tr_b16 v[30:31], v132 offset:1024
    s_waitcnt lgkmcnt(8)
    v_mfma_f32_16x16x32_bf16 v[196:199], v[36:39], v[84:87], v[196:199]
    ds_read_b128 v[124:127], v21 offset:32768
    ds_read_b128 v[128:131], v21 offset:34816
    v_mfma_f32_16x16x32_bf16 v[200:203], v[36:39], v[88:91], v[200:203]
    ds_read_b64_tr_b16 v[32:33], v132 offset:8192
    ds_read_b64_tr_b16 v[34:35], v132 offset:9216
    v_mfma_f32_16x16x32_bf16 v[196:199], v[40:43], v[92:95], v[196:199]
    ds_read_b64_tr_b16 v[36:37], v133 offset:0
    v_mfma_f32_16x16x32_bf16 v[200:203], v[40:43], v[96:99], v[200:203]
    ds_read_b64_tr_b16 v[38:39], v133 offset:1024
    s_waitcnt lgkmcnt(10)
    v_mfma_f32_16x16x32_bf16 v[204:207], v[44:47], v[84:87], v[204:207]
    ds_read_b64_tr_b16 v[40:41], v133 offset:8192
    v_mfma_f32_16x16x32_bf16 v[208:211], v[44:47], v[88:91], v[208:211]
    ds_read_b64_tr_b16 v[42:43], v133 offset:9216
    v_mfma_f32_16x16x32_bf16 v[204:207], v[48:51], v[92:95], v[204:207]
    ds_read_b64_tr_b16 v[44:45], v134 offset:0
    v_mfma_f32_16x16x32_bf16 v[208:211], v[48:51], v[96:99], v[208:211]
    ds_read_b64_tr_b16 v[46:47], v134 offset:1024
    s_waitcnt lgkmcnt(6)
    v_mfma_f32_16x16x32_bf16 v[148:151], v[28:31], v[116:119], v[148:151]
    ds_read_b64_tr_b16 v[48:49], v134 offset:8192
    v_mfma_f32_16x16x32_bf16 v[152:155], v[28:31], v[120:123], v[152:155]
    ds_read_b64_tr_b16 v[50:51], v134 offset:9216
    v_mfma_f32_16x16x32_bf16 v[148:151], v[32:35], v[124:127], v[148:151]
    ds_read_b64_tr_b16 v[28:29], v135 offset:0
    v_mfma_f32_16x16x32_bf16 v[152:155], v[32:35], v[128:131], v[152:155]
    ds_read_b64_tr_b16 v[30:31], v135 offset:1024
    s_load_dwordx2 s[96:97], s[16:17], s92
    s_waitcnt lgkmcnt(6)
    v_mfma_f32_16x16x32_bf16 v[156:159], v[36:39], v[116:119], v[156:159]
    ds_read_b64_tr_b16 v[32:33], v135 offset:8192
    v_mfma_f32_16x16x32_bf16 v[160:163], v[36:39], v[120:123], v[160:163]
    ds_read_b64_tr_b16 v[34:35], v135 offset:9216
    v_mfma_f32_16x16x32_bf16 v[156:159], v[40:43], v[124:127], v[156:159]
    ds_read_b64_tr_b16 v[36:37], v136 offset:0
    v_mfma_f32_16x16x32_bf16 v[160:163], v[40:43], v[128:131], v[160:163]
    ds_read_b64_tr_b16 v[38:39], v136 offset:1024
    s_waitcnt lgkmcnt(6)
    v_mfma_f32_16x16x32_bf16 v[164:167], v[44:47], v[116:119], v[164:167]
    ds_read_b64_tr_b16 v[40:41], v136 offset:8192
    v_mfma_f32_16x16x32_bf16 v[168:171], v[44:47], v[120:123], v[168:171]
    ds_read_b64_tr_b16 v[42:43], v136 offset:9216
    v_mfma_f32_16x16x32_bf16 v[164:167], v[48:51], v[124:127], v[164:167]
    ds_read_b64_tr_b16 v[44:45], v137 offset:0
    v_mfma_f32_16x16x32_bf16 v[168:171], v[48:51], v[128:131], v[168:171]
    ds_read_b64_tr_b16 v[46:47], v137 offset:1024
    s_waitcnt lgkmcnt(6)
    v_mfma_f32_16x16x32_bf16 v[172:175], v[28:31], v[116:119], v[172:175]
    ds_read_b64_tr_b16 v[48:49], v137 offset:8192
    v_mfma_f32_16x16x32_bf16 v[176:179], v[28:31], v[120:123], v[176:179]
    ds_read_b64_tr_b16 v[50:51], v137 offset:9216
    v_mfma_f32_16x16x32_bf16 v[172:175], v[32:35], v[124:127], v[172:175]
    ds_read_b64_tr_b16 v[28:29], v138 offset:0
    v_mfma_f32_16x16x32_bf16 v[176:179], v[32:35], v[128:131], v[176:179]
    ds_read_b64_tr_b16 v[30:31], v138 offset:1024
    s_waitcnt lgkmcnt(6)
    v_mfma_f32_16x16x32_bf16 v[180:183], v[36:39], v[116:119], v[180:183]
    ds_read_b64_tr_b16 v[32:33], v138 offset:8192
    v_mfma_f32_16x16x32_bf16 v[184:187], v[36:39], v[120:123], v[184:187]
    ds_read_b64_tr_b16 v[34:35], v138 offset:9216
    v_mfma_f32_16x16x32_bf16 v[180:183], v[40:43], v[124:127], v[180:183]
    ds_read_b64_tr_b16 v[36:37], v139 offset:0
    v_mfma_f32_16x16x32_bf16 v[184:187], v[40:43], v[128:131], v[184:187]
    ds_read_b64_tr_b16 v[38:39], v139 offset:1024
    s_waitcnt lgkmcnt(6)
    v_mfma_f32_16x16x32_bf16 v[188:191], v[44:47], v[116:119], v[188:191]
    ds_read_b64_tr_b16 v[40:41], v139 offset:8192
    v_mfma_f32_16x16x32_bf16 v[192:195], v[44:47], v[120:123], v[192:195]
    ds_read_b64_tr_b16 v[42:43], v139 offset:9216
    v_mfma_f32_16x16x32_bf16 v[188:191], v[48:51], v[124:127], v[188:191]
    s_barrier
    s_waitcnt lgkmcnt(0)
    ds_read_b128 v[84:87], v20 offset:16384
    ds_read_b128 v[88:91], v20 offset:18432
    v_mfma_f32_16x16x32_bf16 v[192:195], v[48:51], v[128:131], v[192:195]
    ds_read_b64_tr_b16 v[44:45], v132 offset:16384
    ds_read_b64_tr_b16 v[46:47], v132 offset:17408
    s_waitcnt lgkmcnt(8)
    v_mfma_f32_16x16x32_bf16 v[196:199], v[28:31], v[116:119], v[196:199]
    ds_read_b128 v[92:95], v21 offset:16384
    ds_read_b128 v[96:99], v21 offset:18432
    v_mfma_f32_16x16x32_bf16 v[200:203], v[28:31], v[120:123], v[200:203]
    ds_read_b64_tr_b16 v[48:49], v132 offset:24576
    ds_read_b64_tr_b16 v[50:51], v132 offset:25600
    v_mfma_f32_16x16x32_bf16 v[196:199], v[32:35], v[124:127], v[196:199]
    ds_read_b64_tr_b16 v[28:29], v133 offset:16384
    v_mfma_f32_16x16x32_bf16 v[200:203], v[32:35], v[128:131], v[200:203]
    ds_read_b64_tr_b16 v[30:31], v133 offset:17408
    s_waitcnt lgkmcnt(10)
    v_mfma_f32_16x16x32_bf16 v[204:207], v[36:39], v[116:119], v[204:207]
    ds_read_b64_tr_b16 v[32:33], v133 offset:24576
    v_mfma_f32_16x16x32_bf16 v[208:211], v[36:39], v[120:123], v[208:211]
    ds_read_b64_tr_b16 v[34:35], v133 offset:25600
    v_mfma_f32_16x16x32_bf16 v[204:207], v[40:43], v[124:127], v[204:207]
    ds_read_b64_tr_b16 v[36:37], v134 offset:16384
    v_mfma_f32_16x16x32_bf16 v[208:211], v[40:43], v[128:131], v[208:211]
    ds_read_b64_tr_b16 v[38:39], v134 offset:17408
    s_waitcnt lgkmcnt(6)
    v_mfma_f32_16x16x32_bf16 v[148:151], v[44:47], v[84:87], v[148:151]
    ds_read_b64_tr_b16 v[40:41], v134 offset:24576
    ds_read_b64_tr_b16 v[42:43], v134 offset:25600
    v_mfma_f32_16x16x32_bf16 v[152:155], v[44:47], v[88:91], v[152:155]
    s_cmp_eq_u32 s96, 0
    s_cbranch_scc1 L_nonzc
L_nonc:
    v_mov_b32 v252, s96
    v_mfma_f32_16x16x32_bf16 v[148:151], v[48:51], v[92:95], v[148:151]
    ds_read_b64_tr_b16 v[44:45], v135 offset:16384
    ds_read_b64_tr_b16 v[46:47], v135 offset:17408
    v_mfma_f32_16x16x32_bf16 v[152:155], v[48:51], v[96:99], v[152:155]
    v_mov_b32 v253, s97
    s_getreg_b32 s98, hwreg(HW_REG_XCC_ID, 0, 4)
    s_waitcnt lgkmcnt(6)
    v_mfma_f32_16x16x32_bf16 v[156:159], v[28:31], v[84:87], v[156:159]
    ds_read_b64_tr_b16 v[48:49], v135 offset:24576
    ds_read_b64_tr_b16 v[50:51], v135 offset:25600
    v_mfma_f32_16x16x32_bf16 v[160:163], v[28:31], v[88:91], v[160:163]
    s_or_b32 s98, s96, s98
    s_mov_b32 s99, s97
    v_mfma_f32_16x16x32_bf16 v[156:159], v[32:35], v[92:95], v[156:159]
    ds_read_b64_tr_b16 v[28:29], v136 offset:16384
    ds_read_b64_tr_b16 v[30:31], v136 offset:17408
    v_mfma_f32_16x16x32_bf16 v[160:163], v[32:35], v[96:99], v[160:163]
    v_mov_b32 v2, s98
    v_mov_b32 v3, s99
    s_waitcnt lgkmcnt(6)
    v_mfma_f32_16x16x32_bf16 v[164:167], v[36:39], v[84:87], v[164:167]
    ds_read_b64_tr_b16 v[32:33], v136 offset:24576
    ds_read_b64_tr_b16 v[34:35], v136 offset:25600
    v_mfma_f32_16x16x32_bf16 v[168:171], v[36:39], v[88:91], v[168:171]
    s_lshl3_add_u32 s3, s24, s93
    s_cmp_eq_u32 s20, 0
    s_cselect_b64 exec, 1, 0
    buffer_store_dwordx2 v[2:3], off, s[48:51], s3 sc1
    s_mov_b64 exec, -1
    v_mfma_f32_16x16x32_bf16 v[164:167], v[40:43], v[92:95], v[164:167]
    ds_read_b64_tr_b16 v[36:37], v137 offset:16384
    v_mfma_f32_16x16x32_bf16 v[168:171], v[40:43], v[96:99], v[168:171]
    ds_read_b64_tr_b16 v[38:39], v137 offset:17408
    s_waitcnt lgkmcnt(6)
    v_mfma_f32_16x16x32_bf16 v[172:175], v[44:47], v[84:87], v[172:175]
    ds_read_b64_tr_b16 v[40:41], v137 offset:24576
    v_mfma_f32_16x16x32_bf16 v[176:179], v[44:47], v[88:91], v[176:179]
    ds_read_b64_tr_b16 v[42:43], v137 offset:25600
    v_mfma_f32_16x16x32_bf16 v[172:175], v[48:51], v[92:95], v[172:175]
    ds_read_b64_tr_b16 v[44:45], v138 offset:16384
    v_mfma_f32_16x16x32_bf16 v[176:179], v[48:51], v[96:99], v[176:179]
    ds_read_b64_tr_b16 v[46:47], v138 offset:17408
    s_waitcnt lgkmcnt(6)
    v_mfma_f32_16x16x32_bf16 v[180:183], v[28:31], v[84:87], v[180:183]
    ds_read_b64_tr_b16 v[48:49], v138 offset:24576
    v_mfma_f32_16x16x32_bf16 v[184:187], v[28:31], v[88:91], v[184:187]
    ds_read_b64_tr_b16 v[50:51], v138 offset:25600
    v_mfma_f32_16x16x32_bf16 v[180:183], v[32:35], v[92:95], v[180:183]
    ds_read_b64_tr_b16 v[28:29], v139 offset:16384
    v_mfma_f32_16x16x32_bf16 v[184:187], v[32:35], v[96:99], v[184:187]
    ds_read_b64_tr_b16 v[30:31], v139 offset:17408
    s_waitcnt lgkmcnt(6)
    v_mfma_f32_16x16x32_bf16 v[188:191], v[36:39], v[84:87], v[188:191]
    ds_read_b64_tr_b16 v[32:33], v139 offset:24576
    v_mfma_f32_16x16x32_bf16 v[192:195], v[36:39], v[88:91], v[192:195]
    ds_read_b64_tr_b16 v[34:35], v139 offset:25600
    v_mfma_f32_16x16x32_bf16 v[188:191], v[40:43], v[92:95], v[188:191]
    s_barrier
    ds_read_b128 v[116:119], v20 offset:0
    ds_read_b128 v[120:123], v20 offset:2048
    v_mfma_f32_16x16x32_bf16 v[192:195], v[40:43], v[96:99], v[192:195]
    ds_read_b64_tr_b16 v[36:37], v132 offset:32768
    ds_read_b64_tr_b16 v[38:39], v132 offset:33792
    s_waitcnt lgkmcnt(8)
    v_mfma_f32_16x16x32_bf16 v[196:199], v[44:47], v[84:87], v[196:199]
    ds_read_b128 v[124:127], v21 offset:0
    ds_read_b128 v[128:131], v21 offset:2048
    v_mfma_f32_16x16x32_bf16 v[200:203], v[44:47], v[88:91], v[200:203]
    ds_read_b64_tr_b16 v[40:41], v132 offset:40960
    ds_read_b64_tr_b16 v[42:43], v132 offset:41984
    v_mfma_f32_16x16x32_bf16 v[196:199], v[48:51], v[92:95], v[196:199]
    ds_read_b64_tr_b16 v[44:45], v133 offset:32768
    v_mfma_f32_16x16x32_bf16 v[200:203], v[48:51], v[96:99], v[200:203]
    ds_read_b64_tr_b16 v[46:47], v133 offset:33792
    s_waitcnt lgkmcnt(10)
    v_mfma_f32_16x16x32_bf16 v[204:207], v[28:31], v[84:87], v[204:207]
    ds_read_b64_tr_b16 v[48:49], v133 offset:40960
    v_mfma_f32_16x16x32_bf16 v[208:211], v[28:31], v[88:91], v[208:211]
    ds_read_b64_tr_b16 v[50:51], v133 offset:41984
    v_mfma_f32_16x16x32_bf16 v[204:207], v[32:35], v[92:95], v[204:207]
    ds_read_b64_tr_b16 v[28:29], v134 offset:32768
    v_mfma_f32_16x16x32_bf16 v[208:211], v[32:35], v[96:99], v[208:211]
    ds_read_b64_tr_b16 v[30:31], v134 offset:33792
    s_waitcnt lgkmcnt(6)
    v_mfma_f32_16x16x32_bf16 v[148:151], v[36:39], v[116:119], v[148:151]
    ds_read_b64_tr_b16 v[32:33], v134 offset:40960
    v_mfma_f32_16x16x32_bf16 v[152:155], v[36:39], v[120:123], v[152:155]
    ds_read_b64_tr_b16 v[34:35], v134 offset:41984
    v_mfma_f32_16x16x32_bf16 v[148:151], v[40:43], v[124:127], v[148:151]
    ds_read_b64_tr_b16 v[36:37], v135 offset:32768
    v_mfma_f32_16x16x32_bf16 v[152:155], v[40:43], v[128:131], v[152:155]
    ds_read_b64_tr_b16 v[38:39], v135 offset:33792
    s_waitcnt lgkmcnt(6)
    v_mfma_f32_16x16x32_bf16 v[156:159], v[44:47], v[116:119], v[156:159]
    ds_read_b64_tr_b16 v[40:41], v135 offset:40960
    v_mfma_f32_16x16x32_bf16 v[160:163], v[44:47], v[120:123], v[160:163]
    ds_read_b64_tr_b16 v[42:43], v135 offset:41984
    v_mfma_f32_16x16x32_bf16 v[156:159], v[48:51], v[124:127], v[156:159]
    ds_read_b64_tr_b16 v[44:45], v136 offset:32768
    v_mfma_f32_16x16x32_bf16 v[160:163], v[48:51], v[128:131], v[160:163]
    ds_read_b64_tr_b16 v[46:47], v136 offset:33792
    s_waitcnt lgkmcnt(6)
    v_mfma_f32_16x16x32_bf16 v[164:167], v[28:31], v[116:119], v[164:167]
    ds_read_b64_tr_b16 v[48:49], v136 offset:40960
    ds_read_b64_tr_b16 v[50:51], v136 offset:41984
    v_mul_f32 v148, s62, v148
    v_mul_f32 v149, s62, v149
    v_mfma_f32_16x16x32_bf16 v[168:171], v[28:31], v[120:123], v[168:171]
    v_mul_f32 v150, s62, v150
    v_mul_f32 v151, s62, v151
    v_mul_f32 v152, s62, v152
    v_mul_f32 v153, s62, v153
    v_mul_f32 v154, s62, v154
    v_mfma_f32_16x16x32_bf16 v[164:167], v[32:35], v[124:127], v[164:167]
    ds_read_b64_tr_b16 v[28:29], v137 offset:32768
    ds_read_b64_tr_b16 v[30:31], v137 offset:33792
    v_mul_f32 v155, s62, v155
    v_cvt_pk_bf16_f32 v52, v148, v149
    v_mfma_f32_16x16x32_bf16 v[168:171], v[32:35], v[128:131], v[168:171]
    v_cvt_pk_bf16_f32 v53, v150, v151
    v_cvt_pk_bf16_f32 v54, v152, v153
    v_cvt_pk_bf16_f32 v55, v154, v155
    v_mul_f32 v156, s62, v156
    v_mul_f32 v157, s62, v157
    s_waitcnt lgkmcnt(6)
    v_mfma_f32_16x16x32_bf16 v[172:175], v[36:39], v[116:119], v[172:175]
    ds_read_b64_tr_b16 v[32:33], v137 offset:40960
    ds_read_b64_tr_b16 v[34:35], v137 offset:41984
    v_permlane16_swap_b32 v52, v54
    v_permlane16_swap_b32 v53, v55
    v_mfma_f32_16x16x32_bf16 v[176:179], v[36:39], v[120:123], v[176:179]
    v_mul_f32 v158, s62, v158
    v_mul_f32 v159, s62, v159
    v_mul_f32 v160, s62, v160
    v_mul_f32 v161, s62, v161
    v_mul_f32 v162, s62, v162
    v_mfma_f32_16x16x32_bf16 v[172:175], v[40:43], v[124:127], v[172:175]
    ds_read_b64_tr_b16 v[36:37], v138 offset:32768
    ds_read_b64_tr_b16 v[38:39], v138 offset:33792
    v_mul_f32 v163, s62, v163
    v_cvt_pk_bf16_f32 v56, v156, v157
    v_mfma_f32_16x16x32_bf16 v[176:179], v[40:43], v[128:131], v[176:179]
    v_cvt_pk_bf16_f32 v57, v158, v159
    v_cvt_pk_bf16_f32 v58, v160, v161
    v_cvt_pk_bf16_f32 v59, v162, v163
    s_nop 0
    v_permlane16_swap_b32 v56, v58
    v_permlane16_swap_b32 v57, v59
    s_waitcnt lgkmcnt(6)
    v_mfma_f32_16x16x32_bf16 v[180:183], v[44:47], v[116:119], v[180:183]
    ds_read_b64_tr_b16 v[40:41], v138 offset:40960
    ds_read_b64_tr_b16 v[42:43], v138 offset:41984
    v_mul_f32 v164, s62, v164
    v_mul_f32 v165, s62, v165
    v_mfma_f32_16x16x32_bf16 v[184:187], v[44:47], v[120:123], v[184:187]
    v_mul_f32 v166, s62, v166
    v_mul_f32 v167, s62, v167
    v_mul_f32 v168, s62, v168
    v_mul_f32 v169, s62, v169
    v_mul_f32 v170, s62, v170
    v_mfma_f32_16x16x32_bf16 v[180:183], v[48:51], v[124:127], v[180:183]
    ds_read_b64_tr_b16 v[44:45], v139 offset:32768
    ds_read_b64_tr_b16 v[46:47], v139 offset:33792
    v_mul_f32 v171, s62, v171
    v_cvt_pk_bf16_f32 v60, v164, v165
    v_mfma_f32_16x16x32_bf16 v[184:187], v[48:51], v[128:131], v[184:187]
    v_cvt_pk_bf16_f32 v61, v166, v167
    v_cvt_pk_bf16_f32 v62, v168, v169
    v_cvt_pk_bf16_f32 v63, v170, v171
    v_mul_f32 v172, s62, v172
    v_mul_f32 v173, s62, v173
    s_waitcnt lgkmcnt(6)
    v_mfma_f32_16x16x32_bf16 v[188:191], v[28:31], v[116:119], v[188:191]
    ds_read_b64_tr_b16 v[48:49], v139 offset:40960
    ds_read_b64_tr_b16 v[50:51], v139 offset:41984
    v_permlane16_swap_b32 v60, v62
    v_permlane16_swap_b32 v61, v63
    v_mfma_f32_16x16x32_bf16 v[192:195], v[28:31], v[120:123], v[192:195]
    v_mul_f32 v174, s62, v174
    v_mul_f32 v175, s62, v175
    v_mul_f32 v176, s62, v176
    v_mul_f32 v177, s62, v177
    v_mul_f32 v178, s62, v178
    v_mfma_f32_16x16x32_bf16 v[188:191], v[32:35], v[124:127], v[188:191]
    s_barrier
    ds_read_b128 v[28:31], v8 offset:49152
    v_mul_f32 v179, s62, v179
    v_cvt_pk_bf16_f32 v64, v172, v173
    v_cvt_pk_bf16_f32 v65, v174, v175
    v_mfma_f32_16x16x32_bf16 v[192:195], v[32:35], v[128:131], v[192:195]
    v_cvt_pk_bf16_f32 v66, v176, v177
    v_cvt_pk_bf16_f32 v67, v178, v179
    s_nop 0
    v_permlane16_swap_b32 v64, v66
    v_permlane16_swap_b32 v65, v67
    s_waitcnt lgkmcnt(5)
    v_mfma_f32_16x16x32_bf16 v[196:199], v[36:39], v[116:119], v[196:199]
    ds_read_b128 v[32:35], v9 offset:49152
    v_mul_f32 v180, s62, v180
    v_mul_f32 v181, s62, v181
    v_mul_f32 v182, s62, v182
    v_mfma_f32_16x16x32_bf16 v[200:203], v[36:39], v[120:123], v[200:203]
    v_mul_f32 v183, s62, v183
    v_mul_f32 v184, s62, v184
    v_mul_f32 v185, s62, v185
    v_mul_f32 v186, s62, v186
    v_mfma_f32_16x16x32_bf16 v[196:199], v[40:43], v[124:127], v[196:199]
    ds_read_b128 v[36:39], v10 offset:49152
    v_mul_f32 v187, s62, v187
    v_cvt_pk_bf16_f32 v68, v180, v181
    v_cvt_pk_bf16_f32 v69, v182, v183
    v_mfma_f32_16x16x32_bf16 v[200:203], v[40:43], v[128:131], v[200:203]
    v_cvt_pk_bf16_f32 v70, v184, v185
    v_cvt_pk_bf16_f32 v71, v186, v187
    v_mul_f32 v188, s62, v188
    v_mul_f32 v189, s62, v189
    s_waitcnt lgkmcnt(3)
    v_mfma_f32_16x16x32_bf16 v[204:207], v[44:47], v[116:119], v[204:207]
    ds_read_b128 v[40:43], v11 offset:49152
    v_permlane16_swap_b32 v68, v70
    v_permlane16_swap_b32 v69, v71
    v_mul_f32 v190, s62, v190
    v_mfma_f32_16x16x32_bf16 v[208:211], v[44:47], v[120:123], v[208:211]
    v_mul_f32 v191, s62, v191
    v_mul_f32 v192, s62, v192
    v_mul_f32 v193, s62, v193
    v_mul_f32 v194, s62, v194
    v_mfma_f32_16x16x32_bf16 v[204:207], v[48:51], v[124:127], v[204:207]
    ds_read_b128 v[44:47], v12 offset:49152
    v_mul_f32 v195, s62, v195
    v_cvt_pk_bf16_f32 v72, v188, v189
    v_cvt_pk_bf16_f32 v73, v190, v191
    v_mfma_f32_16x16x32_bf16 v[208:211], v[48:51], v[128:131], v[208:211]
    v_cvt_pk_bf16_f32 v74, v192, v193
    v_cvt_pk_bf16_f32 v75, v194, v195
    s_nop 0
    v_permlane16_swap_b32 v72, v74
    v_permlane16_swap_b32 v73, v75
    s_waitcnt lgkmcnt(3)
    v_mfma_f32_32x32x16_bf16 v[100:115], v[28:31], v[52:55], 0
    ds_read_b128 v[48:51], v13 offset:49152
    v_mul_f32 v196, s62, v196
    v_mul_f32 v197, s62, v197
    v_mul_f32 v198, s62, v198
    v_mul_f32 v199, s62, v199
    v_mul_f32 v200, s62, v200
    v_mul_f32 v201, s62, v201
    v_mul_f32 v202, s62, v202
    v_mfma_f32_32x32x16_bf16 v[100:115], v[32:35], v[56:59], v[100:115]
    ds_read_b128 v[28:31], v14 offset:49152
    v_mul_f32 v203, s62, v203
    v_cvt_pk_bf16_f32 v76, v196, v197
    v_cvt_pk_bf16_f32 v77, v198, v199
    v_cvt_pk_bf16_f32 v78, v200, v201
    v_cvt_pk_bf16_f32 v79, v202, v203
    v_mul_f32 v204, s62, v204
    v_mul_f32 v205, s62, v205
    s_waitcnt lgkmcnt(3)
    v_mfma_f32_32x32x16_bf16 v[100:115], v[36:39], v[60:63], v[100:115]
    ds_read_b128 v[32:35], v15 offset:49152
    v_permlane16_swap_b32 v76, v78
    v_permlane16_swap_b32 v77, v79
    v_mul_f32 v206, s62, v206
    v_mul_f32 v207, s62, v207
    v_mul_f32 v208, s62, v208
    v_mul_f32 v209, s62, v209
    v_mul_f32 v210, s62, v210
    v_mfma_f32_32x32x16_bf16 v[100:115], v[40:43], v[64:67], v[100:115]
    ds_read_b128 v[36:39], v8 offset:57344
    v_mul_f32 v211, s62, v211
    v_cvt_pk_bf16_f32 v80, v204, v205
    v_cvt_pk_bf16_f32 v81, v206, v207
    v_cvt_pk_bf16_f32 v82, v208, v209
    v_cvt_pk_bf16_f32 v83, v210, v211
    s_nop 0
    v_permlane16_swap_b32 v80, v82
    v_permlane16_swap_b32 v81, v83
    s_waitcnt lgkmcnt(3)
    v_mfma_f32_32x32x16_bf16 v[100:115], v[44:47], v[68:71], v[100:115]
    ds_read_b128 v[40:43], v9 offset:57344
    v_mfma_f32_32x32x16_bf16 v[100:115], v[48:51], v[72:75], v[100:115]
    ds_read_b128 v[44:47], v10 offset:57344
    s_waitcnt lgkmcnt(3)
    v_mfma_f32_32x32x16_bf16 v[100:115], v[28:31], v[76:79], v[100:115]
    ds_read_b128 v[48:51], v11 offset:57344
    v_sub_u32 v16, v16, v7
    v_sub_u32 v17, v17, v7
    v_sub_u32 v18, v18, v7
    v_sub_u32 v19, v19, v7
    v_mfma_f32_32x32x16_bf16 v[100:115], v[32:35], v[80:83], v[100:115]
    ds_read_b128 v[28:31], v12 offset:57344
    s_waitcnt lgkmcnt(3)
    v_mfma_f32_32x32x16_bf16 v[116:131], v[36:39], v[52:55], 0
    ds_read_b128 v[32:35], v13 offset:57344
    v_mfma_f32_32x32x16_bf16 v[116:131], v[40:43], v[56:59], v[116:131]
    ds_read_b128 v[36:39], v14 offset:57344
    s_waitcnt lgkmcnt(3)
    v_mfma_f32_32x32x16_bf16 v[116:131], v[44:47], v[60:63], v[116:131]
    ds_read_b128 v[40:43], v15 offset:57344
    s_nop 2
    v_max3_f32 v26, v100, v101, v102
    v_max3_f32 v26, v26, v103, v104
    v_max3_f32 v26, v26, v105, v106
    v_max3_f32 v26, v26, v107, v108
    v_max3_f32 v26, v26, v109, v110
    v_mfma_f32_32x32x16_bf16 v[116:131], v[48:51], v[64:67], v[116:131]
    s_barrier
    ds_read_b128 v[44:47], v8 offset:32768
    v_max3_f32 v26, v26, v111, v112
    v_max3_f32 v26, v26, v113, v114
    v_max_f32 v26, v26, v115
    v_mov_b32 v27, v26
    s_nop 1
    v_permlane32_swap_b32 v26, v27
    s_waitcnt lgkmcnt(3)
    v_mfma_f32_32x32x16_bf16 v[116:131], v[28:31], v[68:71], v[116:131]
    ds_read_b64_tr_b16 v[48:49], v16 offset:0
    ds_read_b64_tr_b16 v[50:51], v16 offset:2048
    v_max_f32 v26, v26, v27
    v_sub_f32 v84, 0, v26
    v_sub_f32 v85, 0, v26
    v_add_f32 v100, v100, v84
    v_add_f32 v101, v101, v84
    v_mfma_f32_32x32x16_bf16 v[116:131], v[32:35], v[72:75], v[116:131]
    ds_read_b128 v[28:31], v9 offset:32768
    v_add_f32 v102, v102, v84
    v_add_f32 v103, v103, v84
    v_add_f32 v104, v104, v84
    v_add_f32 v105, v105, v84
    v_add_f32 v106, v106, v84
    s_waitcnt lgkmcnt(4)
    v_mfma_f32_32x32x16_bf16 v[116:131], v[36:39], v[76:79], v[116:131]
    ds_read_b64_tr_b16 v[32:33], v16 offset:4096
    ds_read_b64_tr_b16 v[34:35], v16 offset:6144
    v_add_f32 v107, v107, v84
    v_add_f32 v108, v108, v84
    v_add_f32 v109, v109, v84
    v_add_f32 v110, v110, v84
    v_add_f32 v111, v111, v84
    v_mfma_f32_32x32x16_bf16 v[116:131], v[40:43], v[80:83], v[116:131]
    ds_read_b128 v[36:39], v10 offset:32768
    v_pk_add_f32 v[112:113], v[112:113], v[84:85]
    v_pk_add_f32 v[114:115], v[114:115], v[84:85]
    v_exp_f32 v100, v100
    v_exp_f32 v101, v101
    v_mov_b64 v[86:87], v[84:85]
    v_exp_f32 v102, v102
    v_exp_f32 v103, v103
    v_mov_b64 v[88:89], v[84:85]
    v_cvt_pk_bf16_f32 v132, v100, v101
    v_pk_add_f32 v[24:25], v[24:25], v[100:101]
    v_exp_f32 v104, v104
    v_exp_f32 v105, v105
    v_mov_b64 v[90:91], v[84:85]
    v_cvt_pk_bf16_f32 v133, v102, v103
    v_pk_add_f32 v[24:25], v[24:25], v[102:103]
    v_exp_f32 v106, v106
    v_exp_f32 v107, v107
    v_mov_b64 v[92:93], v[84:85]
    v_cvt_pk_bf16_f32 v134, v104, v105
    v_pk_add_f32 v[24:25], v[24:25], v[104:105]
    v_exp_f32 v108, v108
    v_exp_f32 v109, v109
    v_mov_b64 v[94:95], v[84:85]
    v_cvt_pk_bf16_f32 v135, v106, v107
    v_pk_add_f32 v[24:25], v[24:25], v[106:107]
    v_exp_f32 v110, v110
    v_exp_f32 v111, v111
    v_mov_b64 v[96:97], v[84:85]
    v_cvt_pk_bf16_f32 v136, v108, v109
    v_pk_add_f32 v[24:25], v[24:25], v[108:109]
    v_exp_f32 v112, v112
    v_exp_f32 v113, v113
    v_mov_b64 v[98:99], v[84:85]
    v_cvt_pk_bf16_f32 v137, v110, v111
    v_pk_add_f32 v[24:25], v[24:25], v[110:111]
    v_exp_f32 v26, v114
    v_exp_f32 v27, v115
    v_pk_add_f32 v[116:117], v[116:117], v[84:85]
    v_cvt_pk_bf16_f32 v138, v112, v113
    v_pk_add_f32 v[24:25], v[24:25], v[112:113]
    v_cvt_pk_bf16_f32 v139, v26, v27
    v_pk_add_f32 v[24:25], v[24:25], v[26:27]
    v_pk_add_f32 v[118:119], v[118:119], v[84:85]
    v_pk_add_f32 v[120:121], v[120:121], v[84:85]
    v_pk_add_f32 v[122:123], v[122:123], v[84:85]
    v_pk_add_f32 v[124:125], v[124:125], v[84:85]
    v_pk_add_f32 v[126:127], v[126:127], v[84:85]
    v_pk_add_f32 v[128:129], v[128:129], v[84:85]
    v_pk_add_f32 v[130:131], v[130:131], v[84:85]
    s_waitcnt lgkmcnt(4)
    v_mfma_f32_32x32x16_bf16 v[100:115], v[44:47], v[52:55], v[84:99]
    ds_read_b64_tr_b16 v[40:41], v17 offset:0
    ds_read_b64_tr_b16 v[42:43], v17 offset:2048
    v_exp_f32 v116, v116
L_t4:
    s_cmp_eq_u32 s100, 1
    s_cbranch_scc1 L_t7
    v_mfma_f32_32x32x16_bf16 v[148:163], v[48:51], v[132:135], 0
    ds_read_b128 v[44:47], v11 offset:32768
    v_add_f32 v24, v24, v116
    v_exp_f32 v117, v117
    s_waitcnt lgkmcnt(4)
    v_mfma_f32_32x32x16_bf16 v[100:115], v[28:31], v[56:59], v[100:115]
    ds_read_b64_tr_b16 v[48:49], v17 offset:4096
    ds_read_b64_tr_b16 v[50:51], v17 offset:6144
    v_add_f32 v25, v25, v117
    v_exp_f32 v118, v118
    v_cvt_pk_bf16_f32 v140, v116, v117
    v_mfma_f32_32x32x16_bf16 v[148:163], v[32:35], v[136:139], v[148:163]
    ds_read_b128 v[28:31], v12 offset:32768
    v_add_f32 v24, v24, v118
    v_exp_f32 v119, v119
    s_waitcnt lgkmcnt(4)
    v_mfma_f32_32x32x16_bf16 v[100:115], v[36:39], v[60:63], v[100:115]
    ds_read_b64_tr_b16 v[32:33], v18 offset:0
    ds_read_b64_tr_b16 v[34:35], v18 offset:2048
    v_add_f32 v25, v25, v119
    v_exp_f32 v120, v120
    v_cvt_pk_bf16_f32 v141, v118, v119
    v_mfma_f32_32x32x16_bf16 v[164:179], v[40:43], v[132:135], 0
    ds_read_b128 v[36:39], v13 offset:32768
    v_add_f32 v24, v24, v120
    v_exp_f32 v121, v121
    s_waitcnt lgkmcnt(4)
    v_mfma_f32_32x32x16_bf16 v[100:115], v[44:47], v[64:67], v[100:115]
    ds_read_b64_tr_b16 v[40:41], v18 offset:4096
    ds_read_b64_tr_b16 v[42:43], v18 offset:6144
    v_add_f32 v25, v25, v121
    v_exp_f32 v122, v122
    v_cvt_pk_bf16_f32 v142, v120, v121
    v_mfma_f32_32x32x16_bf16 v[164:179], v[48:51], v[136:139], v[164:179]
    ds_read_b128 v[44:47], v14 offset:32768
    v_add_f32 v24, v24, v122
    v_exp_f32 v123, v123
    s_waitcnt lgkmcnt(4)
    v_mfma_f32_32x32x16_bf16 v[100:115], v[28:31], v[68:71], v[100:115]
    ds_read_b64_tr_b16 v[48:49], v19 offset:0
    ds_read_b64_tr_b16 v[50:51], v19 offset:2048
    v_add_f32 v25, v25, v123
    v_exp_f32 v124, v124
    v_cvt_pk_bf16_f32 v143, v122, v123
    v_mfma_f32_32x32x16_bf16 v[180:195], v[32:35], v[132:135], 0
    ds_read_b128 v[28:31], v15 offset:32768
    v_add_f32 v24, v24, v124
    v_exp_f32 v125, v125
    s_waitcnt lgkmcnt(4)
    v_mfma_f32_32x32x16_bf16 v[100:115], v[36:39], v[72:75], v[100:115]
    ds_read_b64_tr_b16 v[32:33], v19 offset:4096
    ds_read_b64_tr_b16 v[34:35], v19 offset:6144
    v_add_f32 v25, v25, v125
    v_exp_f32 v126, v126
    v_cvt_pk_bf16_f32 v144, v124, v125
    v_mfma_f32_32x32x16_bf16 v[180:195], v[40:43], v[136:139], v[180:195]
    ds_read_b128 v[36:39], v8 offset:40960
    v_add_f32 v24, v24, v126
    v_exp_f32 v127, v127
    s_waitcnt lgkmcnt(4)
    v_mfma_f32_32x32x16_bf16 v[100:115], v[44:47], v[76:79], v[100:115]
    ds_read_b64_tr_b16 v[40:41], v16 offset:8192
    ds_read_b64_tr_b16 v[42:43], v16 offset:10240
    v_add_f32 v25, v25, v127
    v_exp_f32 v128, v128
    v_cvt_pk_bf16_f32 v145, v126, v127
    v_mfma_f32_32x32x16_bf16 v[196:211], v[48:51], v[132:135], 0
    ds_read_b128 v[44:47], v9 offset:40960
    v_add_f32 v24, v24, v128
    v_exp_f32 v129, v129
    s_waitcnt lgkmcnt(4)
    v_mfma_f32_32x32x16_bf16 v[100:115], v[28:31], v[80:83], v[100:115]
    ds_read_b64_tr_b16 v[48:49], v16 offset:12288
    ds_read_b64_tr_b16 v[50:51], v16 offset:14336
    v_add_f32 v25, v25, v129
    v_exp_f32 v26, v130
    v_cvt_pk_bf16_f32 v146, v128, v129
    v_mfma_f32_32x32x16_bf16 v[196:211], v[32:35], v[136:139], v[196:211]
    ds_read_b128 v[28:31], v10 offset:40960
    v_add_f32 v24, v24, v26
    v_exp_f32 v27, v131
    s_waitcnt lgkmcnt(4)
    v_mfma_f32_32x32x16_bf16 v[116:131], v[36:39], v[52:55], v[84:99]
    ds_read_b64_tr_b16 v[32:33], v17 offset:8192
    ds_read_b64_tr_b16 v[34:35], v17 offset:10240
    v_add_f32 v25, v25, v27
    v_cvt_pk_bf16_f32 v147, v26, v27
    v_exp_f32 v100, v100
    v_mfma_f32_32x32x16_bf16 v[148:163], v[40:43], v[140:143], v[148:163]
    ds_read_b128 v[36:39], v11 offset:40960
    v_add_f32 v24, v24, v100
    v_exp_f32 v101, v101
    s_waitcnt lgkmcnt(4)
    v_mfma_f32_32x32x16_bf16 v[116:131], v[44:47], v[56:59], v[116:131]
    ds_read_b64_tr_b16 v[40:41], v17 offset:12288
    ds_read_b64_tr_b16 v[42:43], v17 offset:14336
    v_add_f32 v25, v25, v101
    v_exp_f32 v102, v102
    v_cvt_pk_bf16_f32 v132, v100, v101
    v_mfma_f32_32x32x16_bf16 v[148:163], v[48:51], v[144:147], v[148:163]
    ds_read_b128 v[44:47], v12 offset:40960
    v_add_f32 v24, v24, v102
    v_exp_f32 v103, v103
    s_waitcnt lgkmcnt(4)
    v_mfma_f32_32x32x16_bf16 v[116:131], v[28:31], v[60:63], v[116:131]
    ds_read_b64_tr_b16 v[48:49], v18 offset:8192
    ds_read_b64_tr_b16 v[50:51], v18 offset:10240
    v_add_f32 v25, v25, v103
    v_exp_f32 v104, v104
    v_cvt_pk_bf16_f32 v133, v102, v103
    v_mfma_f32_32x32x16_bf16 v[164:179], v[32:35], v[140:143], v[164:179]
    ds_read_b128 v[28:31], v13 offset:40960
    v_add_f32 v24, v24, v104
    v_exp_f32 v105, v105
    s_waitcnt lgkmcnt(4)
    v_mfma_f32_32x32x16_bf16 v[116:131], v[36:39], v[64:67], v[116:131]
    ds_read_b64_tr_b16 v[32:33], v18 offset:12288
    ds_read_b64_tr_b16 v[34:35], v18 offset:14336
    v_add_f32 v25, v25, v105
    v_exp_f32 v106, v106
    v_cvt_pk_bf16_f32 v134, v104, v105
    v_mfma_f32_32x32x16_bf16 v[164:179], v[40:43], v[144:147], v[164:179]
    ds_read_b128 v[36:39], v14 offset:40960
    v_add_f32 v24, v24, v106
    v_exp_f32 v107, v107
    s_waitcnt lgkmcnt(4)
    v_mfma_f32_32x32x16_bf16 v[116:131], v[44:47], v[68:71], v[116:131]
    ds_read_b64_tr_b16 v[40:41], v19 offset:8192
    ds_read_b64_tr_b16 v[42:43], v19 offset:10240
    v_add_f32 v25, v25, v107
    v_exp_f32 v108, v108
    v_cvt_pk_bf16_f32 v135, v106, v107
    v_mfma_f32_32x32x16_bf16 v[180:195], v[48:51], v[140:143], v[180:195]
    ds_read_b128 v[44:47], v15 offset:40960
    v_add_f32 v24, v24, v108
    v_exp_f32 v109, v109
    s_waitcnt lgkmcnt(4)
    v_mfma_f32_32x32x16_bf16 v[116:131], v[28:31], v[72:75], v[116:131]
    ds_read_b64_tr_b16 v[48:49], v19 offset:12288
    ds_read_b64_tr_b16 v[50:51], v19 offset:14336
    v_add_f32 v25, v25, v109
    v_exp_f32 v110, v110
    v_cvt_pk_bf16_f32 v136, v108, v109
    v_mfma_f32_32x32x16_bf16 v[180:195], v[32:35], v[144:147], v[180:195]
    s_barrier
    ds_read_b128 v[28:31], v8 offset:16384
    v_add_f32 v24, v24, v110
    v_exp_f32 v111, v111
    s_waitcnt lgkmcnt(4)
    v_mfma_f32_32x32x16_bf16 v[116:131], v[36:39], v[76:79], v[116:131]
    ds_read_b64_tr_b16 v[32:33], v16 offset:16384
    ds_read_b64_tr_b16 v[34:35], v16 offset:18432
    v_add_f32 v25, v25, v111
    v_exp_f32 v112, v112
    v_cvt_pk_bf16_f32 v137, v110, v111
    v_mfma_f32_32x32x16_bf16 v[196:211], v[40:43], v[140:143], v[196:211]
    ds_read_b128 v[36:39], v9 offset:16384
    v_add_f32 v24, v24, v112
    v_exp_f32 v113, v113
    s_waitcnt lgkmcnt(4)
    v_mfma_f32_32x32x16_bf16 v[116:131], v[44:47], v[80:83], v[116:131]
    ds_read_b64_tr_b16 v[40:41], v16 offset:20480
    ds_read_b64_tr_b16 v[42:43], v16 offset:22528
    v_add_f32 v25, v25, v113
    v_exp_f32 v26, v114
    v_cvt_pk_bf16_f32 v138, v112, v113
    v_mfma_f32_32x32x16_bf16 v[196:211], v[48:51], v[144:147], v[196:211]
    ds_read_b128 v[44:47], v10 offset:16384
    v_add_f32 v24, v24, v26
    v_exp_f32 v27, v115
    s_waitcnt lgkmcnt(4)
    v_mfma_f32_32x32x16_bf16 v[100:115], v[28:31], v[52:55], v[84:99]
    ds_read_b64_tr_b16 v[48:49], v17 offset:16384
    ds_read_b64_tr_b16 v[50:51], v17 offset:18432
    v_add_f32 v25, v25, v27
    v_cvt_pk_bf16_f32 v139, v26, v27
    v_exp_f32 v116, v116
    v_mfma_f32_32x32x16_bf16 v[148:163], v[32:35], v[132:135], v[148:163]
    ds_read_b128 v[28:31], v11 offset:16384
    v_add_f32 v24, v24, v116
    v_exp_f32 v117, v117
    s_waitcnt lgkmcnt(4)
    v_mfma_f32_32x32x16_bf16 v[100:115], v[36:39], v[56:59], v[100:115]
    ds_read_b64_tr_b16 v[32:33], v17 offset:20480
    ds_read_b64_tr_b16 v[34:35], v17 offset:22528
    v_add_f32 v25, v25, v117
    v_exp_f32 v118, v118
    v_cvt_pk_bf16_f32 v140, v116, v117
    v_mfma_f32_32x32x16_bf16 v[148:163], v[40:43], v[136:139], v[148:163]
    ds_read_b128 v[36:39], v12 offset:16384
    v_add_f32 v24, v24, v118
    v_exp_f32 v119, v119
    s_waitcnt lgkmcnt(4)
    v_mfma_f32_32x32x16_bf16 v[100:115], v[44:47], v[60:63], v[100:115]
    ds_read_b64_tr_b16 v[40:41], v18 offset:16384
    ds_read_b64_tr_b16 v[42:43], v18 offset:18432
    v_add_f32 v25, v25, v119
    v_exp_f32 v120, v120
    v_cvt_pk_bf16_f32 v141, v118, v119
    v_mfma_f32_32x32x16_bf16 v[164:179], v[48:51], v[132:135], v[164:179]
    ds_read_b128 v[44:47], v13 offset:16384
    v_add_f32 v24, v24, v120
    v_exp_f32 v121, v121
    s_waitcnt lgkmcnt(4)
    v_mfma_f32_32x32x16_bf16 v[100:115], v[28:31], v[64:67], v[100:115]
    ds_read_b64_tr_b16 v[48:49], v18 offset:20480
    ds_read_b64_tr_b16 v[50:51], v18 offset:22528
    v_add_f32 v25, v25, v121
    v_exp_f32 v122, v122
    v_cvt_pk_bf16_f32 v142, v120, v121
    v_mfma_f32_32x32x16_bf16 v[164:179], v[32:35], v[136:139], v[164:179]
    ds_read_b128 v[28:31], v14 offset:16384
    v_add_f32 v24, v24, v122
    v_exp_f32 v123, v123
    s_waitcnt lgkmcnt(4)
    v_mfma_f32_32x32x16_bf16 v[100:115], v[36:39], v[68:71], v[100:115]
    ds_read_b64_tr_b16 v[32:33], v19 offset:16384
    ds_read_b64_tr_b16 v[34:35], v19 offset:18432
    v_add_f32 v25, v25, v123
    v_exp_f32 v124, v124
    v_cvt_pk_bf16_f32 v143, v122, v123
    v_mfma_f32_32x32x16_bf16 v[180:195], v[40:43], v[132:135], v[180:195]
    ds_read_b128 v[36:39], v15 offset:16384
    v_add_f32 v24, v24, v124
    v_exp_f32 v125, v125
    s_waitcnt lgkmcnt(4)
    v_mfma_f32_32x32x16_bf16 v[100:115], v[44:47], v[72:75], v[100:115]
    ds_read_b64_tr_b16 v[40:41], v19 offset:20480
    ds_read_b64_tr_b16 v[42:43], v19 offset:22528
    v_add_f32 v25, v25, v125
    v_exp_f32 v126, v126
    v_cvt_pk_bf16_f32 v144, v124, v125
    v_mfma_f32_32x32x16_bf16 v[180:195], v[48:51], v[136:139], v[180:195]
    ds_read_b128 v[44:47], v8 offset:24576
    v_add_f32 v24, v24, v126
    v_exp_f32 v127, v127
    s_waitcnt lgkmcnt(4)
    v_mfma_f32_32x32x16_bf16 v[100:115], v[28:31], v[76:79], v[100:115]
    ds_read_b64_tr_b16 v[48:49], v16 offset:24576
    ds_read_b64_tr_b16 v[50:51], v16 offset:26624
    v_add_f32 v25, v25, v127
    v_exp_f32 v128, v128
    v_cvt_pk_bf16_f32 v145, v126, v127
    v_mfma_f32_32x32x16_bf16 v[196:211], v[32:35], v[132:135], v[196:211]
    ds_read_b128 v[28:31], v9 offset:24576
    v_add_f32 v24, v24, v128
    v_exp_f32 v129, v129
    s_waitcnt lgkmcnt(4)
    v_mfma_f32_32x32x16_bf16 v[100:115], v[36:39], v[80:83], v[100:115]
    ds_read_b64_tr_b16 v[32:33], v16 offset:28672
    ds_read_b64_tr_b16 v[34:35], v16 offset:30720
    v_add_f32 v25, v25, v129
    v_exp_f32 v26, v130
    v_cvt_pk_bf16_f32 v146, v128, v129
    v_mfma_f32_32x32x16_bf16 v[196:211], v[40:43], v[136:139], v[196:211]
    ds_read_b128 v[36:39], v10 offset:24576
    v_add_f32 v24, v24, v26
    v_exp_f32 v27, v131
    s_waitcnt lgkmcnt(4)
    v_mfma_f32_32x32x16_bf16 v[116:131], v[44:47], v[52:55], v[84:99]
    ds_read_b64_tr_b16 v[40:41], v17 offset:24576
    ds_read_b64_tr_b16 v[42:43], v17 offset:26624
    v_add_f32 v25, v25, v27
    v_cvt_pk_bf16_f32 v147, v26, v27
    v_exp_f32 v100, v100
    v_mfma_f32_32x32x16_bf16 v[148:163], v[48:51], v[140:143], v[148:163]
    ds_read_b128 v[44:47], v11 offset:24576
    v_add_f32 v24, v24, v100
    v_exp_f32 v101, v101
    s_waitcnt lgkmcnt(4)
    v_mfma_f32_32x32x16_bf16 v[116:131], v[28:31], v[56:59], v[116:131]
    ds_read_b64_tr_b16 v[48:49], v17 offset:28672
    ds_read_b64_tr_b16 v[50:51], v17 offset:30720
    v_add_f32 v25, v25, v101
    v_exp_f32 v102, v102
    v_cvt_pk_bf16_f32 v132, v100, v101
    v_mfma_f32_32x32x16_bf16 v[148:163], v[32:35], v[144:147], v[148:163]
    ds_read_b128 v[28:31], v12 offset:24576
    v_add_f32 v24, v24, v102
    v_exp_f32 v103, v103
    s_waitcnt lgkmcnt(4)
    v_mfma_f32_32x32x16_bf16 v[116:131], v[36:39], v[60:63], v[116:131]
    ds_read_b64_tr_b16 v[32:33], v18 offset:24576
    ds_read_b64_tr_b16 v[34:35], v18 offset:26624
    v_add_f32 v25, v25, v103
    v_exp_f32 v104, v104
    v_cvt_pk_bf16_f32 v133, v102, v103
    v_mfma_f32_32x32x16_bf16 v[164:179], v[40:43], v[140:143], v[164:179]
    ds_read_b128 v[36:39], v13 offset:24576
    v_add_f32 v24, v24, v104
    v_exp_f32 v105, v105
    s_waitcnt lgkmcnt(4)
    v_mfma_f32_32x32x16_bf16 v[116:131], v[44:47], v[64:67], v[116:131]
    ds_read_b64_tr_b16 v[40:41], v18 offset:28672
    ds_read_b64_tr_b16 v[42:43], v18 offset:30720
    v_add_f32 v25, v25, v105
    v_exp_f32 v106, v106
    v_cvt_pk_bf16_f32 v134, v104, v105
    v_mfma_f32_32x32x16_bf16 v[164:179], v[48:51], v[144:147], v[164:179]
    ds_read_b128 v[44:47], v14 offset:24576
    v_add_f32 v24, v24, v106
    v_exp_f32 v107, v107
    s_waitcnt lgkmcnt(4)
    v_mfma_f32_32x32x16_bf16 v[116:131], v[28:31], v[68:71], v[116:131]
    ds_read_b64_tr_b16 v[48:49], v19 offset:24576
    ds_read_b64_tr_b16 v[50:51], v19 offset:26624
    v_add_f32 v25, v25, v107
    v_exp_f32 v108, v108
    v_cvt_pk_bf16_f32 v135, v106, v107
    v_mfma_f32_32x32x16_bf16 v[180:195], v[32:35], v[140:143], v[180:195]
    ds_read_b128 v[28:31], v15 offset:24576
    v_add_f32 v24, v24, v108
    v_exp_f32 v109, v109
    s_waitcnt lgkmcnt(4)
    v_mfma_f32_32x32x16_bf16 v[116:131], v[36:39], v[72:75], v[116:131]
    ds_read_b64_tr_b16 v[32:33], v19 offset:28672
    ds_read_b64_tr_b16 v[34:35], v19 offset:30720
    v_add_f32 v25, v25, v109
    v_exp_f32 v110, v110
    v_cvt_pk_bf16_f32 v136, v108, v109
    v_mfma_f32_32x32x16_bf16 v[180:195], v[40:43], v[144:147], v[180:195]
    s_barrier
    ds_read_b128 v[36:39], v8 offset:0
    v_add_f32 v24, v24, v110
    v_exp_f32 v111, v111
    s_waitcnt lgkmcnt(4)
    v_mfma_f32_32x32x16_bf16 v[116:131], v[44:47], v[76:79], v[116:131]
    ds_read_b64_tr_b16 v[40:41], v16 offset:32768
    ds_read_b64_tr_b16 v[42:43], v16 offset:34816
    v_add_f32 v25, v25, v111
    v_exp_f32 v112, v112
    v_cvt_pk_bf16_f32 v137, v110, v111
    v_mfma_f32_32x32x16_bf16 v[196:211], v[48:51], v[140:143], v[196:211]
    ds_read_b128 v[44:47], v9 offset:0
    v_add_f32 v24, v24, v112
    v_exp_f32 v113, v113
    s_waitcnt lgkmcnt(4)
    v_mfma_f32_32x32x16_bf16 v[116:131], v[28:31], v[80:83], v[116:131]
    ds_read_b64_tr_b16 v[48:49], v16 offset:36864
    ds_read_b64_tr_b16 v[50:51], v16 offset:38912
    v_add_f32 v25, v25, v113
    v_exp_f32 v26, v114
    v_cvt_pk_bf16_f32 v138, v112, v113
    v_mfma_f32_32x32x16_bf16 v[196:211], v[32:35], v[144:147], v[196:211]
    ds_read_b128 v[28:31], v10 offset:0
    v_add_f32 v24, v24, v26
    v_exp_f32 v27, v115
    s_waitcnt lgkmcnt(4)
    v_mfma_f32_32x32x16_bf16 v[100:115], v[36:39], v[52:55], v[84:99]
    ds_read_b64_tr_b16 v[32:33], v17 offset:32768
    ds_read_b64_tr_b16 v[34:35], v17 offset:34816
    v_add_f32 v25, v25, v27
    v_cvt_pk_bf16_f32 v139, v26, v27
    v_exp_f32 v116, v116
    v_mfma_f32_32x32x16_bf16 v[148:163], v[40:43], v[132:135], v[148:163]
    ds_read_b128 v[36:39], v11 offset:0
    v_add_f32 v24, v24, v116
    v_exp_f32 v117, v117
    s_waitcnt lgkmcnt(4)
    v_mfma_f32_32x32x16_bf16 v[100:115], v[44:47], v[56:59], v[100:115]
    ds_read_b64_tr_b16 v[40:41], v17 offset:36864
    ds_read_b64_tr_b16 v[42:43], v17 offset:38912
    v_add_f32 v25, v25, v117
    v_exp_f32 v118, v118
    v_cvt_pk_bf16_f32 v140, v116, v117
    v_mfma_f32_32x32x16_bf16 v[148:163], v[48:51], v[136:139], v[148:163]
    ds_read_b128 v[44:47], v12 offset:0
    v_add_f32 v24, v24, v118
    v_exp_f32 v119, v119
    s_waitcnt lgkmcnt(4)
    v_mfma_f32_32x32x16_bf16 v[100:115], v[28:31], v[60:63], v[100:115]
    ds_read_b64_tr_b16 v[48:49], v18 offset:32768
    ds_read_b64_tr_b16 v[50:51], v18 offset:34816
    v_add_f32 v25, v25, v119
    v_exp_f32 v120, v120
    v_cvt_pk_bf16_f32 v141, v118, v119
    v_mfma_f32_32x32x16_bf16 v[164:179], v[32:35], v[132:135], v[164:179]
    ds_read_b128 v[28:31], v13 offset:0
    v_add_f32 v24, v24, v120
    v_exp_f32 v121, v121
    s_waitcnt lgkmcnt(4)
    v_mfma_f32_32x32x16_bf16 v[100:115], v[36:39], v[64:67], v[100:115]
    ds_read_b64_tr_b16 v[32:33], v18 offset:36864
    ds_read_b64_tr_b16 v[34:35], v18 offset:38912
    v_add_f32 v25, v25, v121
    v_exp_f32 v122, v122
    v_cvt_pk_bf16_f32 v142, v120, v121
    v_mfma_f32_32x32x16_bf16 v[164:179], v[40:43], v[136:139], v[164:179]
    ds_read_b128 v[36:39], v14 offset:0
    v_add_f32 v24, v24, v122
    v_exp_f32 v123, v123
    s_waitcnt lgkmcnt(4)
    v_mfma_f32_32x32x16_bf16 v[100:115], v[44:47], v[68:71], v[100:115]
    ds_read_b64_tr_b16 v[40:41], v19 offset:32768
    ds_read_b64_tr_b16 v[42:43], v19 offset:34816
    v_add_f32 v25, v25, v123
    v_exp_f32 v124, v124
    v_cvt_pk_bf16_f32 v143, v122, v123
    v_mfma_f32_32x32x16_bf16 v[180:195], v[48:51], v[132:135], v[180:195]
    ds_read_b128 v[44:47], v15 offset:0
    v_add_f32 v24, v24, v124
    v_exp_f32 v125, v125
    s_waitcnt lgkmcnt(4)
    v_mfma_f32_32x32x16_bf16 v[100:115], v[28:31], v[72:75], v[100:115]
    ds_read_b64_tr_b16 v[48:49], v19 offset:36864
    ds_read_b64_tr_b16 v[50:51], v19 offset:38912
    v_add_f32 v25, v25, v125
    v_exp_f32 v126, v126
    v_cvt_pk_bf16_f32 v144, v124, v125
    v_mfma_f32_32x32x16_bf16 v[180:195], v[32:35], v[136:139], v[180:195]
    ds_read_b128 v[28:31], v8 offset:8192
    v_add_f32 v24, v24, v126
    v_exp_f32 v127, v127
    s_waitcnt lgkmcnt(4)
    v_mfma_f32_32x32x16_bf16 v[100:115], v[36:39], v[76:79], v[100:115]
    ds_read_b64_tr_b16 v[32:33], v16 offset:40960
    ds_read_b64_tr_b16 v[34:35], v16 offset:43008
    v_add_f32 v25, v25, v127
    v_exp_f32 v128, v128
    v_cvt_pk_bf16_f32 v145, v126, v127
    v_mfma_f32_32x32x16_bf16 v[196:211], v[40:43], v[132:135], v[196:211]
    ds_read_b128 v[36:39], v9 offset:8192
    v_add_f32 v24, v24, v128
    v_exp_f32 v129, v129
    s_waitcnt lgkmcnt(4)
    v_mfma_f32_32x32x16_bf16 v[100:115], v[44:47], v[80:83], v[100:115]
    ds_read_b64_tr_b16 v[40:41], v16 offset:45056
    ds_read_b64_tr_b16 v[42:43], v16 offset:47104
    v_add_f32 v25, v25, v129
    v_exp_f32 v26, v130
    v_cvt_pk_bf16_f32 v146, v128, v129
    v_mfma_f32_32x32x16_bf16 v[196:211], v[48:51], v[136:139], v[196:211]
    ds_read_b128 v[44:47], v10 offset:8192
    v_add_f32 v24, v24, v26
    v_exp_f32 v27, v131
    s_waitcnt lgkmcnt(4)
    v_mfma_f32_32x32x16_bf16 v[116:131], v[28:31], v[52:55], v[84:99]
    ds_read_b64_tr_b16 v[48:49], v17 offset:40960
    ds_read_b64_tr_b16 v[50:51], v17 offset:43008
    v_add_f32 v25, v25, v27
    v_cvt_pk_bf16_f32 v147, v26, v27
    v_exp_f32 v100, v100
    v_mfma_f32_32x32x16_bf16 v[148:163], v[32:35], v[140:143], v[148:163]
    ds_read_b128 v[28:31], v11 offset:8192
    v_add_f32 v24, v24, v100
    v_exp_f32 v101, v101
    s_waitcnt lgkmcnt(4)
    v_mfma_f32_32x32x16_bf16 v[116:131], v[36:39], v[56:59], v[116:131]
    ds_read_b64_tr_b16 v[32:33], v17 offset:45056
    ds_read_b64_tr_b16 v[34:35], v17 offset:47104
    v_add_f32 v25, v25, v101
    v_exp_f32 v102, v102
    v_cvt_pk_bf16_f32 v132, v100, v101
    v_mfma_f32_32x32x16_bf16 v[148:163], v[40:43], v[144:147], v[148:163]
    ds_read_b128 v[36:39], v12 offset:8192
    v_add_f32 v24, v24, v102
    v_exp_f32 v103, v103
    s_waitcnt lgkmcnt(4)
    v_mfma_f32_32x32x16_bf16 v[116:131], v[44:47], v[60:63], v[116:131]
    ds_read_b64_tr_b16 v[40:41], v18 offset:40960
    ds_read_b64_tr_b16 v[42:43], v18 offset:43008
    v_add_f32 v25, v25, v103
    v_exp_f32 v104, v104
    v_cvt_pk_bf16_f32 v133, v102, v103
    v_mfma_f32_32x32x16_bf16 v[164:179], v[48:51], v[140:143], v[164:179]
    ds_read_b128 v[44:47], v13 offset:8192
    v_add_f32 v24, v24, v104
    v_exp_f32 v105, v105
    s_waitcnt lgkmcnt(4)
    v_mfma_f32_32x32x16_bf16 v[116:131], v[28:31], v[64:67], v[116:131]
    ds_read_b64_tr_b16 v[48:49], v18 offset:45056
    ds_read_b64_tr_b16 v[50:51], v18 offset:47104
    v_add_f32 v25, v25, v105
    v_exp_f32 v106, v106
    v_cvt_pk_bf16_f32 v134, v104, v105
    v_mfma_f32_32x32x16_bf16 v[164:179], v[32:35], v[144:147], v[164:179]
    ds_read_b128 v[28:31], v14 offset:8192
    v_add_f32 v24, v24, v106
    v_exp_f32 v107, v107
    s_waitcnt lgkmcnt(4)
    v_mfma_f32_32x32x16_bf16 v[116:131], v[36:39], v[68:71], v[116:131]
    ds_read_b64_tr_b16 v[32:33], v19 offset:40960
    ds_read_b64_tr_b16 v[34:35], v19 offset:43008
    v_add_f32 v25, v25, v107
    v_exp_f32 v108, v108
    v_cvt_pk_bf16_f32 v135, v106, v107
    v_mfma_f32_32x32x16_bf16 v[180:195], v[40:43], v[140:143], v[180:195]
    ds_read_b128 v[36:39], v15 offset:8192
    v_add_f32 v24, v24, v108
    v_exp_f32 v109, v109
    s_waitcnt lgkmcnt(4)
    v_mfma_f32_32x32x16_bf16 v[116:131], v[44:47], v[72:75], v[116:131]
    ds_read_b64_tr_b16 v[40:41], v19 offset:45056
    ds_read_b64_tr_b16 v[42:43], v19 offset:47104
    v_add_f32 v25, v25, v109
    v_exp_f32 v110, v110
    v_cvt_pk_bf16_f32 v136, v108, v109
    v_mfma_f32_32x32x16_bf16 v[180:195], v[48:51], v[144:147], v[180:195]
    s_barrier
    ds_read_b128 v[44:47], v8 offset:49152
    v_add_f32 v24, v24, v110
    v_exp_f32 v111, v111
    s_waitcnt lgkmcnt(4)
    v_mfma_f32_32x32x16_bf16 v[116:131], v[28:31], v[76:79], v[116:131]
    ds_read_b64_tr_b16 v[48:49], v16 offset:49152
    ds_read_b64_tr_b16 v[50:51], v16 offset:51200
    v_add_f32 v25, v25, v111
    v_exp_f32 v112, v112
    v_cvt_pk_bf16_f32 v137, v110, v111
    v_mfma_f32_32x32x16_bf16 v[196:211], v[32:35], v[140:143], v[196:211]
    ds_read_b128 v[28:31], v9 offset:49152
    v_add_f32 v24, v24, v112
    v_exp_f32 v113, v113
    s_waitcnt lgkmcnt(4)
    v_mfma_f32_32x32x16_bf16 v[116:131], v[36:39], v[80:83], v[116:131]
    ds_read_b64_tr_b16 v[32:33], v16 offset:53248
    ds_read_b64_tr_b16 v[34:35], v16 offset:55296
    v_add_f32 v25, v25, v113
    v_exp_f32 v26, v114
    v_cvt_pk_bf16_f32 v138, v112, v113
    v_mfma_f32_32x32x16_bf16 v[196:211], v[40:43], v[144:147], v[196:211]
    ds_read_b128 v[36:39], v10 offset:49152
    v_add_f32 v24, v24, v26
    v_exp_f32 v27, v115
    s_waitcnt lgkmcnt(4)
    v_mfma_f32_32x32x16_bf16 v[100:115], v[44:47], v[52:55], v[84:99]
    ds_read_b64_tr_b16 v[40:41], v17 offset:49152
    ds_read_b64_tr_b16 v[42:43], v17 offset:51200
    v_add_f32 v25, v25, v27
    v_cvt_pk_bf16_f32 v139, v26, v27
    v_exp_f32 v116, v116
    v_mfma_f32_32x32x16_bf16 v[148:163], v[48:51], v[132:135], v[148:163]
    ds_read_b128 v[44:47], v11 offset:49152
    v_add_f32 v24, v24, v116
    v_exp_f32 v117, v117
    s_waitcnt lgkmcnt(4)
    v_mfma_f32_32x32x16_bf16 v[100:115], v[28:31], v[56:59], v[100:115]
    ds_read_b64_tr_b16 v[48:49], v17 offset:53248
    ds_read_b64_tr_b16 v[50:51], v17 offset:55296
    v_add_f32 v25, v25, v117
    v_exp_f32 v118, v118
    v_cvt_pk_bf16_f32 v140, v116, v117
    v_mfma_f32_32x32x16_bf16 v[148:163], v[32:35], v[136:139], v[148:163]
    ds_read_b128 v[28:31], v12 offset:49152
    v_add_f32 v24, v24, v118
    v_exp_f32 v119, v119
    s_waitcnt lgkmcnt(4)
    v_mfma_f32_32x32x16_bf16 v[100:115], v[36:39], v[60:63], v[100:115]
    ds_read_b64_tr_b16 v[32:33], v18 offset:49152
    ds_read_b64_tr_b16 v[34:35], v18 offset:51200
    v_add_f32 v25, v25, v119
    v_exp_f32 v120, v120
    v_cvt_pk_bf16_f32 v141, v118, v119
    v_mfma_f32_32x32x16_bf16 v[164:179], v[40:43], v[132:135], v[164:179]
    ds_read_b128 v[36:39], v13 offset:49152
    v_add_f32 v24, v24, v120
    v_exp_f32 v121, v121
    s_waitcnt lgkmcnt(4)
    v_mfma_f32_32x32x16_bf16 v[100:115], v[44:47], v[64:67], v[100:115]
    ds_read_b64_tr_b16 v[40:41], v18 offset:53248
    ds_read_b64_tr_b16 v[42:43], v18 offset:55296
    v_add_f32 v25, v25, v121
    v_exp_f32 v122, v122
    v_cvt_pk_bf16_f32 v142, v120, v121
    v_mfma_f32_32x32x16_bf16 v[164:179], v[48:51], v[136:139], v[164:179]
    ds_read_b128 v[44:47], v14 offset:49152
    v_add_f32 v24, v24, v122
    v_exp_f32 v123, v123
    s_waitcnt lgkmcnt(4)
    v_mfma_f32_32x32x16_bf16 v[100:115], v[28:31], v[68:71], v[100:115]
    ds_read_b64_tr_b16 v[48:49], v19 offset:49152
    ds_read_b64_tr_b16 v[50:51], v19 offset:51200
    v_add_f32 v25, v25, v123
    v_exp_f32 v124, v124
    v_cvt_pk_bf16_f32 v143, v122, v123
    v_mfma_f32_32x32x16_bf16 v[180:195], v[32:35], v[132:135], v[180:195]
    ds_read_b128 v[28:31], v15 offset:49152
    v_add_f32 v24, v24, v124
    v_exp_f32 v125, v125
    s_waitcnt lgkmcnt(4)
    v_mfma_f32_32x32x16_bf16 v[100:115], v[36:39], v[72:75], v[100:115]
    ds_read_b64_tr_b16 v[32:33], v19 offset:53248
    ds_read_b64_tr_b16 v[34:35], v19 offset:55296
    v_add_f32 v25, v25, v125
    v_exp_f32 v126, v126
    v_cvt_pk_bf16_f32 v144, v124, v125
    v_mfma_f32_32x32x16_bf16 v[180:195], v[40:43], v[136:139], v[180:195]
    ds_read_b128 v[36:39], v8 offset:57344
    v_add_f32 v24, v24, v126
    v_exp_f32 v127, v127
    s_waitcnt lgkmcnt(4)
    v_mfma_f32_32x32x16_bf16 v[100:115], v[44:47], v[76:79], v[100:115]
    ds_read_b64_tr_b16 v[40:41], v16 offset:57344
    ds_read_b64_tr_b16 v[42:43], v16 offset:59392
    v_add_f32 v25, v25, v127
    v_exp_f32 v128, v128
    v_cvt_pk_bf16_f32 v145, v126, v127
    v_mfma_f32_32x32x16_bf16 v[196:211], v[48:51], v[132:135], v[196:211]
    ds_read_b128 v[44:47], v9 offset:57344
    v_add_f32 v24, v24, v128
    v_exp_f32 v129, v129
    s_waitcnt lgkmcnt(4)
    v_mfma_f32_32x32x16_bf16 v[100:115], v[28:31], v[80:83], v[100:115]
    ds_read_b64_tr_b16 v[48:49], v16 offset:61440
    ds_read_b64_tr_b16 v[50:51], v16 offset:63488
    v_add_f32 v25, v25, v129
    v_exp_f32 v26, v130
    v_cvt_pk_bf16_f32 v146, v128, v129
    v_mfma_f32_32x32x16_bf16 v[196:211], v[32:35], v[136:139], v[196:211]
    ds_read_b128 v[28:31], v10 offset:57344
    v_add_f32 v24, v24, v26
    v_exp_f32 v27, v131
    s_waitcnt lgkmcnt(4)
    v_mfma_f32_32x32x16_bf16 v[116:131], v[36:39], v[52:55], v[84:99]
    ds_read_b64_tr_b16 v[32:33], v17 offset:57344
    ds_read_b64_tr_b16 v[34:35], v17 offset:59392
    v_add_f32 v25, v25, v27
    v_cvt_pk_bf16_f32 v147, v26, v27
    v_exp_f32 v100, v100
    v_mfma_f32_32x32x16_bf16 v[148:163], v[40:43], v[140:143], v[148:163]
    ds_read_b128 v[36:39], v11 offset:57344
    v_add_f32 v24, v24, v100
    v_exp_f32 v101, v101
    s_waitcnt lgkmcnt(4)
    v_mfma_f32_32x32x16_bf16 v[116:131], v[44:47], v[56:59], v[116:131]
    ds_read_b64_tr_b16 v[40:41], v17 offset:61440
    ds_read_b64_tr_b16 v[42:43], v17 offset:63488
    v_add_f32 v25, v25, v101
    v_exp_f32 v102, v102
    v_cvt_pk_bf16_f32 v132, v100, v101
    v_mfma_f32_32x32x16_bf16 v[148:163], v[48:51], v[144:147], v[148:163]
    ds_read_b128 v[44:47], v12 offset:57344
    v_add_f32 v24, v24, v102
    v_exp_f32 v103, v103
    s_waitcnt lgkmcnt(4)
    v_mfma_f32_32x32x16_bf16 v[116:131], v[28:31], v[60:63], v[116:131]
    ds_read_b64_tr_b16 v[48:49], v18 offset:57344
    ds_read_b64_tr_b16 v[50:51], v18 offset:59392
    v_add_f32 v25, v25, v103
    v_exp_f32 v104, v104
    v_cvt_pk_bf16_f32 v133, v102, v103
    v_mfma_f32_32x32x16_bf16 v[164:179], v[32:35], v[140:143], v[164:179]
    ds_read_b128 v[28:31], v13 offset:57344
    v_add_f32 v24, v24, v104
    v_exp_f32 v105, v105
    s_waitcnt lgkmcnt(4)
    v_mfma_f32_32x32x16_bf16 v[116:131], v[36:39], v[64:67], v[116:131]
    ds_read_b64_tr_b16 v[32:33], v18 offset:61440
    ds_read_b64_tr_b16 v[34:35], v18 offset:63488
    v_add_f32 v25, v25, v105
    v_exp_f32 v106, v106
    v_cvt_pk_bf16_f32 v134, v104, v105
    v_mfma_f32_32x32x16_bf16 v[164:179], v[40:43], v[144:147], v[164:179]
    ds_read_b128 v[36:39], v14 offset:57344
    v_add_f32 v24, v24, v106
    v_exp_f32 v107, v107
    s_waitcnt lgkmcnt(4)
    v_mfma_f32_32x32x16_bf16 v[116:131], v[44:47], v[68:71], v[116:131]
    ds_read_b64_tr_b16 v[40:41], v19 offset:57344
    ds_read_b64_tr_b16 v[42:43], v19 offset:59392
    v_add_f32 v25, v25, v107
    v_exp_f32 v108, v108
    v_cvt_pk_bf16_f32 v135, v106, v107
L_t5:
    s_cmp_eq_u32 s100, 1
    s_cbranch_scc1 L_wc
    v_mfma_f32_32x32x16_bf16 v[180:195], v[48:51], v[140:143], v[180:195]
    ds_read_b128 v[44:47], v15 offset:57344
    v_add_f32 v24, v24, v108
    v_exp_f32 v109, v109
    s_waitcnt lgkmcnt(4)
    v_mfma_f32_32x32x16_bf16 v[116:131], v[28:31], v[72:75], v[116:131]
    ds_read_b64_tr_b16 v[48:49], v19 offset:61440
    ds_read_b64_tr_b16 v[50:51], v19 offset:63488
    v_add_f32 v25, v25, v109
    v_exp_f32 v110, v110
    v_cvt_pk_bf16_f32 v136, v108, v109
    v_mfma_f32_32x32x16_bf16 v[180:195], v[32:35], v[144:147], v[180:195]
    s_barrier
    ds_read_b128 v[28:31], v8 offset:32768
    v_add_f32 v24, v24, v110
    v_exp_f32 v111, v111
    s_waitcnt lgkmcnt(4)
    v_mfma_f32_32x32x16_bf16 v[116:131], v[36:39], v[76:79], v[116:131]
    ds_read_b64_tr_b16 v[32:33], v16 offset:0
    ds_read_b64_tr_b16 v[34:35], v16 offset:2048
    v_add_f32 v25, v25, v111
    v_exp_f32 v112, v112
    v_cvt_pk_bf16_f32 v137, v110, v111
    v_mfma_f32_32x32x16_bf16 v[196:211], v[40:43], v[140:143], v[196:211]
    ds_read_b128 v[36:39], v9 offset:32768
    v_add_f32 v24, v24, v112
    v_exp_f32 v113, v113
    s_waitcnt lgkmcnt(4)
    v_mfma_f32_32x32x16_bf16 v[116:131], v[44:47], v[80:83], v[116:131]
    ds_read_b64_tr_b16 v[40:41], v16 offset:4096
    ds_read_b64_tr_b16 v[42:43], v16 offset:6144
    v_add_f32 v25, v25, v113
    v_exp_f32 v26, v114
    v_cvt_pk_bf16_f32 v138, v112, v113
    v_mfma_f32_32x32x16_bf16 v[196:211], v[48:51], v[144:147], v[196:211]
    ds_read_b128 v[44:47], v10 offset:32768
    v_add_f32 v24, v24, v26
    v_exp_f32 v27, v115
    s_waitcnt lgkmcnt(4)
    v_mfma_f32_32x32x16_bf16 v[100:115], v[28:31], v[52:55], v[84:99]
    ds_read_b64_tr_b16 v[48:49], v17 offset:0
    ds_read_b64_tr_b16 v[50:51], v17 offset:2048
    v_add_f32 v25, v25, v27
    v_cvt_pk_bf16_f32 v139, v26, v27
    v_exp_f32 v116, v116
    v_mfma_f32_32x32x16_bf16 v[148:163], v[32:35], v[132:135], v[148:163]
    ds_read_b128 v[28:31], v11 offset:32768
    v_add_f32 v24, v24, v116
    v_exp_f32 v117, v117
    s_waitcnt lgkmcnt(4)
    v_mfma_f32_32x32x16_bf16 v[100:115], v[36:39], v[56:59], v[100:115]
    ds_read_b64_tr_b16 v[32:33], v17 offset:4096
    ds_read_b64_tr_b16 v[34:35], v17 offset:6144
    v_add_f32 v25, v25, v117
    v_exp_f32 v118, v118
    v_cvt_pk_bf16_f32 v140, v116, v117
    v_mfma_f32_32x32x16_bf16 v[148:163], v[40:43], v[136:139], v[148:163]
    ds_read_b128 v[36:39], v12 offset:32768
    v_add_f32 v24, v24, v118
    v_exp_f32 v119, v119
    s_waitcnt lgkmcnt(4)
    v_mfma_f32_32x32x16_bf16 v[100:115], v[44:47], v[60:63], v[100:115]
    ds_read_b64_tr_b16 v[40:41], v18 offset:0
    ds_read_b64_tr_b16 v[42:43], v18 offset:2048
    v_add_f32 v25, v25, v119
    v_exp_f32 v120, v120
    v_cvt_pk_bf16_f32 v141, v118, v119
    v_mfma_f32_32x32x16_bf16 v[164:179], v[48:51], v[132:135], v[164:179]
    ds_read_b128 v[44:47], v13 offset:32768
    v_add_f32 v24, v24, v120
    v_exp_f32 v121, v121
    s_waitcnt lgkmcnt(4)
    v_mfma_f32_32x32x16_bf16 v[100:115], v[28:31], v[64:67], v[100:115]
    ds_read_b64_tr_b16 v[48:49], v18 offset:4096
    ds_read_b64_tr_b16 v[50:51], v18 offset:6144
    v_add_f32 v25, v25, v121
    v_exp_f32 v122, v122
    v_cvt_pk_bf16_f32 v142, v120, v121
    v_mfma_f32_32x32x16_bf16 v[164:179], v[32:35], v[136:139], v[164:179]
    ds_read_b128 v[28:31], v14 offset:32768
    v_add_f32 v24, v24, v122
    v_exp_f32 v123, v123
    s_waitcnt lgkmcnt(4)
    v_mfma_f32_32x32x16_bf16 v[100:115], v[36:39], v[68:71], v[100:115]
    ds_read_b64_tr_b16 v[32:33], v19 offset:0
    ds_read_b64_tr_b16 v[34:35], v19 offset:2048
    v_add_f32 v25, v25, v123
    v_exp_f32 v124, v124
    v_cvt_pk_bf16_f32 v143, v122, v123
    v_mfma_f32_32x32x16_bf16 v[180:195], v[40:43], v[132:135], v[180:195]
    ds_read_b128 v[36:39], v15 offset:32768
    v_add_f32 v24, v24, v124
    v_exp_f32 v125, v125
    s_waitcnt lgkmcnt(4)
    v_mfma_f32_32x32x16_bf16 v[100:115], v[44:47], v[72:75], v[100:115]
    ds_read_b64_tr_b16 v[40:41], v19 offset:4096
    ds_read_b64_tr_b16 v[42:43], v19 offset:6144
    v_add_f32 v25, v25, v125
    v_exp_f32 v126, v126
    v_cvt_pk_bf16_f32 v144, v124, v125
    v_mfma_f32_32x32x16_bf16 v[180:195], v[48:51], v[136:139], v[180:195]
    ds_read_b128 v[44:47], v8 offset:40960
    v_add_f32 v24, v24, v126
    v_exp_f32 v127, v127
    s_waitcnt lgkmcnt(4)
    v_mfma_f32_32x32x16_bf16 v[100:115], v[28:31], v[76:79], v[100:115]
    ds_read_b64_tr_b16 v[48:49], v16 offset:8192
    ds_read_b64_tr_b16 v[50:51], v16 offset:10240
    v_add_f32 v25, v25, v127
    v_exp_f32 v128, v128
    v_cvt_pk_bf16_f32 v145, v126, v127
    v_mfma_f32_32x32x16_bf16 v[196:211], v[32:35], v[132:135], v[196:211]
    ds_read_b128 v[28:31], v9 offset:40960
    v_add_f32 v24, v24, v128
    v_exp_f32 v129, v129
    s_waitcnt lgkmcnt(4)
    v_mfma_f32_32x32x16_bf16 v[100:115], v[36:39], v[80:83], v[100:115]
    ds_read_b64_tr_b16 v[32:33], v16 offset:12288
    ds_read_b64_tr_b16 v[34:35], v16 offset:14336
    v_add_f32 v25, v25, v129
    v_exp_f32 v26, v130
    v_cvt_pk_bf16_f32 v146, v128, v129
    v_mfma_f32_32x32x16_bf16 v[196:211], v[40:43], v[136:139], v[196:211]
    ds_read_b128 v[36:39], v10 offset:40960
    v_add_f32 v24, v24, v26
    v_exp_f32 v27, v131
    s_waitcnt lgkmcnt(4)
    v_mfma_f32_32x32x16_bf16 v[116:131], v[44:47], v[52:55], v[84:99]
    ds_read_b64_tr_b16 v[40:41], v17 offset:8192
    ds_read_b64_tr_b16 v[42:43], v17 offset:10240
    v_add_f32 v25, v25, v27
    v_cvt_pk_bf16_f32 v147, v26, v27
    v_exp_f32 v100, v100
    v_mfma_f32_32x32x16_bf16 v[148:163], v[48:51], v[140:143], v[148:163]
    ds_read_b128 v[44:47], v11 offset:40960
    v_add_f32 v24, v24, v100
    v_exp_f32 v101, v101
    s_waitcnt lgkmcnt(4)
    v_mfma_f32_32x32x16_bf16 v[116:131], v[28:31], v[56:59], v[116:131]
    ds_read_b64_tr_b16 v[48:49], v17 offset:12288
    ds_read_b64_tr_b16 v[50:51], v17 offset:14336
    v_add_f32 v25, v25, v101
    v_exp_f32 v102, v102
    v_cvt_pk_bf16_f32 v132, v100, v101
    v_mfma_f32_32x32x16_bf16 v[148:163], v[32:35], v[144:147], v[148:163]
    ds_read_b128 v[28:31], v12 offset:40960
    v_add_f32 v24, v24, v102
    v_exp_f32 v103, v103
    s_waitcnt lgkmcnt(4)
    v_mfma_f32_32x32x16_bf16 v[116:131], v[36:39], v[60:63], v[116:131]
    ds_read_b64_tr_b16 v[32:33], v18 offset:8192
    ds_read_b64_tr_b16 v[34:35], v18 offset:10240
    v_add_f32 v25, v25, v103
    v_exp_f32 v104, v104
    v_cvt_pk_bf16_f32 v133, v102, v103
    v_mfma_f32_32x32x16_bf16 v[164:179], v[40:43], v[140:143], v[164:179]
    ds_read_b128 v[36:39], v13 offset:40960
    v_add_f32 v24, v24, v104
    v_exp_f32 v105, v105
    s_waitcnt lgkmcnt(4)
    v_mfma_f32_32x32x16_bf16 v[116:131], v[44:47], v[64:67], v[116:131]
    ds_read_b64_tr_b16 v[40:41], v18 offset:12288
    ds_read_b64_tr_b16 v[42:43], v18 offset:14336
    v_add_f32 v25, v25, v105
    v_exp_f32 v106, v106
    v_cvt_pk_bf16_f32 v134, v104, v105
    v_mfma_f32_32x32x16_bf16 v[164:179], v[48:51], v[144:147], v[164:179]
    ds_read_b128 v[44:47], v14 offset:40960
    v_add_f32 v24, v24, v106
    v_exp_f32 v107, v107
    s_waitcnt lgkmcnt(4)
    v_mfma_f32_32x32x16_bf16 v[116:131], v[28:31], v[68:71], v[116:131]
    ds_read_b64_tr_b16 v[48:49], v19 offset:8192
    ds_read_b64_tr_b16 v[50:51], v19 offset:10240
    v_add_f32 v25, v25, v107
    v_exp_f32 v108, v108
    v_cvt_pk_bf16_f32 v135, v106, v107
    v_mfma_f32_32x32x16_bf16 v[180:195], v[32:35], v[140:143], v[180:195]
    ds_read_b128 v[28:31], v15 offset:40960
    v_add_f32 v24, v24, v108
    v_exp_f32 v109, v109
    s_waitcnt lgkmcnt(4)
    v_mfma_f32_32x32x16_bf16 v[116:131], v[36:39], v[72:75], v[116:131]
    ds_read_b64_tr_b16 v[32:33], v19 offset:12288
    ds_read_b64_tr_b16 v[34:35], v19 offset:14336
    v_add_f32 v25, v25, v109
    v_exp_f32 v110, v110
    v_cvt_pk_bf16_f32 v136, v108, v109
    v_mfma_f32_32x32x16_bf16 v[180:195], v[40:43], v[144:147], v[180:195]
    s_barrier
    ds_read_b128 v[36:39], v8 offset:16384
    v_add_f32 v24, v24, v110
    v_exp_f32 v111, v111
    s_waitcnt lgkmcnt(4)
    v_mfma_f32_32x32x16_bf16 v[116:131], v[44:47], v[76:79], v[116:131]
    ds_read_b64_tr_b16 v[40:41], v16 offset:16384
    ds_read_b64_tr_b16 v[42:43], v16 offset:18432
    v_add_f32 v25, v25, v111
    v_exp_f32 v112, v112
    v_cvt_pk_bf16_f32 v137, v110, v111
    v_mfma_f32_32x32x16_bf16 v[196:211], v[48:51], v[140:143], v[196:211]
    ds_read_b128 v[44:47], v9 offset:16384
    v_add_f32 v24, v24, v112
    v_exp_f32 v113, v113
    s_waitcnt lgkmcnt(4)
    v_mfma_f32_32x32x16_bf16 v[116:131], v[28:31], v[80:83], v[116:131]
    ds_read_b64_tr_b16 v[48:49], v16 offset:20480
    ds_read_b64_tr_b16 v[50:51], v16 offset:22528
    v_add_f32 v25, v25, v113
    v_exp_f32 v26, v114
    v_cvt_pk_bf16_f32 v138, v112, v113
    v_mfma_f32_32x32x16_bf16 v[196:211], v[32:35], v[144:147], v[196:211]
    ds_read_b128 v[28:31], v10 offset:16384
    v_add_f32 v24, v24, v26
    v_exp_f32 v27, v115
    s_waitcnt lgkmcnt(4)
    v_mfma_f32_32x32x16_bf16 v[100:115], v[36:39], v[52:55], v[84:99]
    ds_read_b64_tr_b16 v[32:33], v17 offset:16384
    ds_read_b64_tr_b16 v[34:35], v17 offset:18432
    v_add_f32 v25, v25, v27
    v_cvt_pk_bf16_f32 v139, v26, v27
    v_exp_f32 v116, v116
    v_mfma_f32_32x32x16_bf16 v[148:163], v[40:43], v[132:135], v[148:163]
    ds_read_b128 v[36:39], v11 offset:16384
    v_add_f32 v24, v24, v116
    v_exp_f32 v117, v117
    s_waitcnt lgkmcnt(4)
    v_mfma_f32_32x32x16_bf16 v[100:115], v[44:47], v[56:59], v[100:115]
    ds_read_b64_tr_b16 v[40:41], v17 offset:20480
    ds_read_b64_tr_b16 v[42:43], v17 offset:22528
    v_add_f32 v25, v25, v117
    v_exp_f32 v118, v118
    v_cvt_pk_bf16_f32 v140, v116, v117
    v_mfma_f32_32x32x16_bf16 v[148:163], v[48:51], v[136:139], v[148:163]
    ds_read_b128 v[44:47], v12 offset:16384
    v_add_f32 v24, v24, v118
    v_exp_f32 v119, v119
    s_waitcnt lgkmcnt(4)
    v_mfma_f32_32x32x16_bf16 v[100:115], v[28:31], v[60:63], v[100:115]
    ds_read_b64_tr_b16 v[48:49], v18 offset:16384
    ds_read_b64_tr_b16 v[50:51], v18 offset:18432
    v_add_f32 v25, v25, v119
    v_exp_f32 v120, v120
    v_cvt_pk_bf16_f32 v141, v118, v119
    v_mfma_f32_32x32x16_bf16 v[164:179], v[32:35], v[132:135], v[164:179]
    ds_read_b128 v[28:31], v13 offset:16384
    v_add_f32 v24, v24, v120
    v_exp_f32 v121, v121
    s_waitcnt lgkmcnt(4)
    v_mfma_f32_32x32x16_bf16 v[100:115], v[36:39], v[64:67], v[100:115]
    ds_read_b64_tr_b16 v[32:33], v18 offset:20480
    ds_read_b64_tr_b16 v[34:35], v18 offset:22528
    v_add_f32 v25, v25, v121
    v_exp_f32 v122, v122
    v_cvt_pk_bf16_f32 v142, v120, v121
    v_mfma_f32_32x32x16_bf16 v[164:179], v[40:43], v[136:139], v[164:179]
    ds_read_b128 v[36:39], v14 offset:16384
    v_add_f32 v24, v24, v122
    v_exp_f32 v123, v123
    s_waitcnt lgkmcnt(4)
    v_mfma_f32_32x32x16_bf16 v[100:115], v[44:47], v[68:71], v[100:115]
    ds_read_b64_tr_b16 v[40:41], v19 offset:16384
    ds_read_b64_tr_b16 v[42:43], v19 offset:18432
    v_add_f32 v25, v25, v123
    v_exp_f32 v124, v124
    v_cvt_pk_bf16_f32 v143, v122, v123
    v_mfma_f32_32x32x16_bf16 v[180:195], v[48:51], v[132:135], v[180:195]
    ds_read_b128 v[44:47], v15 offset:16384
    v_add_f32 v24, v24, v124
    v_exp_f32 v125, v125
    s_waitcnt lgkmcnt(4)
    v_mfma_f32_32x32x16_bf16 v[100:115], v[28:31], v[72:75], v[100:115]
    ds_read_b64_tr_b16 v[48:49], v19 offset:20480
    ds_read_b64_tr_b16 v[50:51], v19 offset:22528
    v_add_f32 v25, v25, v125
    v_exp_f32 v126, v126
    v_cvt_pk_bf16_f32 v144, v124, v125
    v_mfma_f32_32x32x16_bf16 v[180:195], v[32:35], v[136:139], v[180:195]
    ds_read_b128 v[28:31], v8 offset:24576
    v_add_f32 v24, v24, v126
    v_exp_f32 v127, v127
    s_waitcnt lgkmcnt(4)
    v_mfma_f32_32x32x16_bf16 v[100:115], v[36:39], v[76:79], v[100:115]
    ds_read_b64_tr_b16 v[32:33], v16 offset:24576
    ds_read_b64_tr_b16 v[34:35], v16 offset:26624
    v_add_f32 v25, v25, v127
    v_exp_f32 v128, v128
    v_cvt_pk_bf16_f32 v145, v126, v127
    v_mfma_f32_32x32x16_bf16 v[196:211], v[40:43], v[132:135], v[196:211]
    ds_read_b128 v[36:39], v9 offset:24576
    v_add_f32 v24, v24, v128
    v_exp_f32 v129, v129
    s_waitcnt lgkmcnt(4)
    v_mfma_f32_32x32x16_bf16 v[100:115], v[44:47], v[80:83], v[100:115]
    ds_read_b64_tr_b16 v[40:41], v16 offset:28672
    ds_read_b64_tr_b16 v[42:43], v16 offset:30720
    v_add_f32 v25, v25, v129
    v_exp_f32 v26, v130
    v_cvt_pk_bf16_f32 v146, v128, v129
    v_mfma_f32_32x32x16_bf16 v[196:211], v[48:51], v[136:139], v[196:211]
    ds_read_b128 v[44:47], v10 offset:24576
    v_add_f32 v24, v24, v26
    v_exp_f32 v27, v131
    s_waitcnt lgkmcnt(4)
    v_mfma_f32_32x32x16_bf16 v[116:131], v[28:31], v[52:55], v[84:99]
    ds_read_b64_tr_b16 v[48:49], v17 offset:24576
    ds_read_b64_tr_b16 v[50:51], v17 offset:26624
    v_add_f32 v25, v25, v27
    v_cvt_pk_bf16_f32 v147, v26, v27
    v_exp_f32 v100, v100
    v_mfma_f32_32x32x16_bf16 v[148:163], v[32:35], v[140:143], v[148:163]
    ds_read_b128 v[28:31], v11 offset:24576
    v_add_f32 v24, v24, v100
    v_exp_f32 v101, v101
    s_waitcnt lgkmcnt(4)
    v_mfma_f32_32x32x16_bf16 v[116:131], v[36:39], v[56:59], v[116:131]
    ds_read_b64_tr_b16 v[32:33], v17 offset:28672
    ds_read_b64_tr_b16 v[34:35], v17 offset:30720
    v_add_f32 v25, v25, v101
    v_exp_f32 v102, v102
    v_cvt_pk_bf16_f32 v132, v100, v101
    v_mfma_f32_32x32x16_bf16 v[148:163], v[40:43], v[144:147], v[148:163]
    ds_read_b128 v[36:39], v12 offset:24576
    v_add_f32 v24, v24, v102
    v_exp_f32 v103, v103
    s_waitcnt lgkmcnt(4)
    v_mfma_f32_32x32x16_bf16 v[116:131], v[44:47], v[60:63], v[116:131]
    ds_read_b64_tr_b16 v[40:41], v18 offset:24576
    ds_read_b64_tr_b16 v[42:43], v18 offset:26624
    v_add_f32 v25, v25, v103
    v_exp_f32 v104, v104
    v_cvt_pk_bf16_f32 v133, v102, v103
    v_mfma_f32_32x32x16_bf16 v[164:179], v[48:51], v[140:143], v[164:179]
    ds_read_b128 v[44:47], v13 offset:24576
    v_add_f32 v24, v24, v104
    v_exp_f32 v105, v105
    s_waitcnt lgkmcnt(4)
    v_mfma_f32_32x32x16_bf16 v[116:131], v[28:31], v[64:67], v[116:131]
    ds_read_b64_tr_b16 v[48:49], v18 offset:28672
    ds_read_b64_tr_b16 v[50:51], v18 offset:30720
    v_add_f32 v25, v25, v105
    v_exp_f32 v106, v106
    v_cvt_pk_bf16_f32 v134, v104, v105
    v_mfma_f32_32x32x16_bf16 v[164:179], v[32:35], v[144:147], v[164:179]
    ds_read_b128 v[28:31], v14 offset:24576
    v_add_f32 v24, v24, v106
    v_exp_f32 v107, v107
    s_waitcnt lgkmcnt(4)
    v_mfma_f32_32x32x16_bf16 v[116:131], v[36:39], v[68:71], v[116:131]
    ds_read_b64_tr_b16 v[32:33], v19 offset:24576
    ds_read_b64_tr_b16 v[34:35], v19 offset:26624
    v_add_f32 v25, v25, v107
    v_exp_f32 v108, v108
    v_cvt_pk_bf16_f32 v135, v106, v107
    v_mfma_f32_32x32x16_bf16 v[180:195], v[40:43], v[140:143], v[180:195]
    ds_read_b128 v[36:39], v15 offset:24576
    v_add_f32 v24, v24, v108
    v_exp_f32 v109, v109
    s_waitcnt lgkmcnt(4)
    v_mfma_f32_32x32x16_bf16 v[116:131], v[44:47], v[72:75], v[116:131]
    ds_read_b64_tr_b16 v[40:41], v19 offset:28672
    ds_read_b64_tr_b16 v[42:43], v19 offset:30720
    v_add_f32 v25, v25, v109
    v_exp_f32 v110, v110
    v_cvt_pk_bf16_f32 v136, v108, v109
    v_mfma_f32_32x32x16_bf16 v[180:195], v[48:51], v[144:147], v[180:195]
    s_barrier
    ds_read_b128 v[44:47], v8 offset:0
    v_add_f32 v24, v24, v110
    v_exp_f32 v111, v111
    s_waitcnt lgkmcnt(4)
    v_mfma_f32_32x32x16_bf16 v[116:131], v[28:31], v[76:79], v[116:131]
    ds_read_b64_tr_b16 v[48:49], v16 offset:32768
    ds_read_b64_tr_b16 v[50:51], v16 offset:34816
    v_add_f32 v25, v25, v111
    v_exp_f32 v112, v112
    v_cvt_pk_bf16_f32 v137, v110, v111
    v_mfma_f32_32x32x16_bf16 v[196:211], v[32:35], v[140:143], v[196:211]
    ds_read_b128 v[28:31], v9 offset:0
    v_add_f32 v24, v24, v112
    v_exp_f32 v113, v113
    s_waitcnt lgkmcnt(4)
    v_mfma_f32_32x32x16_bf16 v[116:131], v[36:39], v[80:83], v[116:131]
    ds_read_b64_tr_b16 v[32:33], v16 offset:36864
    ds_read_b64_tr_b16 v[34:35], v16 offset:38912
    v_add_f32 v25, v25, v113
    v_exp_f32 v26, v114
    v_cvt_pk_bf16_f32 v138, v112, v113
    v_mfma_f32_32x32x16_bf16 v[196:211], v[40:43], v[144:147], v[196:211]
    ds_read_b128 v[36:39], v10 offset:0
    v_add_f32 v24, v24, v26
    v_exp_f32 v27, v115
    s_waitcnt lgkmcnt(4)
    v_mfma_f32_32x32x16_bf16 v[100:115], v[44:47], v[52:55], v[84:99]
    ds_read_b64_tr_b16 v[40:41], v17 offset:32768
    ds_read_b64_tr_b16 v[42:43], v17 offset:34816
    v_add_f32 v25, v25, v27
    v_cvt_pk_bf16_f32 v139, v26, v27
    v_exp_f32 v116, v116
    v_mfma_f32_32x32x16_bf16 v[148:163], v[48:51], v[132:135], v[148:163]
    ds_read_b128 v[44:47], v11 offset:0
    v_add_f32 v24, v24, v116
    v_exp_f32 v117, v117
    s_waitcnt lgkmcnt(4)
    v_mfma_f32_32x32x16_bf16 v[100:115], v[28:31], v[56:59], v[100:115]
    ds_read_b64_tr_b16 v[48:49], v17 offset:36864
    ds_read_b64_tr_b16 v[50:51], v17 offset:38912
    v_add_f32 v25, v25, v117
    v_exp_f32 v118, v118
    v_cvt_pk_bf16_f32 v140, v116, v117
    v_mfma_f32_32x32x16_bf16 v[148:163], v[32:35], v[136:139], v[148:163]
    ds_read_b128 v[28:31], v12 offset:0
    s_load_dwordx8 s[4:11], s[18:19], s93
    v_add_f32 v24, v24, v118
    v_exp_f32 v119, v119
    s_waitcnt lgkmcnt(4)
    v_mfma_f32_32x32x16_bf16 v[100:115], v[36:39], v[60:63], v[100:115]
    ds_read_b64_tr_b16 v[32:33], v18 offset:32768
    ds_read_b64_tr_b16 v[34:35], v18 offset:34816
    v_add_f32 v25, v25, v119
    v_exp_f32 v120, v120
    v_cvt_pk_bf16_f32 v141, v118, v119
    v_mfma_f32_32x32x16_bf16 v[164:179], v[40:43], v[132:135], v[164:179]
    ds_read_b128 v[36:39], v13 offset:0
    v_add_f32 v24, v24, v120
    v_exp_f32 v121, v121
    s_waitcnt lgkmcnt(4)
    v_mfma_f32_32x32x16_bf16 v[100:115], v[44:47], v[64:67], v[100:115]
    ds_read_b64_tr_b16 v[40:41], v18 offset:36864
    ds_read_b64_tr_b16 v[42:43], v18 offset:38912
    v_add_f32 v25, v25, v121
    v_exp_f32 v122, v122
    v_cvt_pk_bf16_f32 v142, v120, v121
    v_mfma_f32_32x32x16_bf16 v[164:179], v[48:51], v[136:139], v[164:179]
    ds_read_b128 v[44:47], v14 offset:0
    v_add_f32 v24, v24, v122
    v_exp_f32 v123, v123
    s_waitcnt lgkmcnt(4)
    v_mfma_f32_32x32x16_bf16 v[100:115], v[28:31], v[68:71], v[100:115]
    ds_read_b64_tr_b16 v[48:49], v19 offset:32768
    ds_read_b64_tr_b16 v[50:51], v19 offset:34816
    v_add_f32 v25, v25, v123
    v_exp_f32 v124, v124
    v_cvt_pk_bf16_f32 v143, v122, v123
    v_mfma_f32_32x32x16_bf16 v[180:195], v[32:35], v[132:135], v[180:195]
    ds_read_b128 v[28:31], v15 offset:0
    v_add_f32 v24, v24, v124
    v_exp_f32 v125, v125
    s_waitcnt lgkmcnt(4)
    v_mfma_f32_32x32x16_bf16 v[100:115], v[36:39], v[72:75], v[100:115]
    ds_read_b64_tr_b16 v[32:33], v19 offset:36864
    ds_read_b64_tr_b16 v[34:35], v19 offset:38912
    v_add_f32 v25, v25, v125
    v_exp_f32 v126, v126
    v_cvt_pk_bf16_f32 v144, v124, v125
    v_mfma_f32_32x32x16_bf16 v[180:195], v[40:43], v[136:139], v[180:195]
    ds_read_b128 v[36:39], v8 offset:8192
    v_add_f32 v24, v24, v126
    v_exp_f32 v127, v127
    s_waitcnt lgkmcnt(4)
    v_mfma_f32_32x32x16_bf16 v[100:115], v[44:47], v[76:79], v[100:115]
    ds_read_b128 v[40:43], v9 offset:8192
    v_add_f32 v25, v25, v127
    v_exp_f32 v128, v128
    v_cvt_pk_bf16_f32 v145, v126, v127
    v_mfma_f32_32x32x16_bf16 v[196:211], v[48:51], v[132:135], v[196:211]
    ds_read_b128 v[44:47], v10 offset:8192
    v_add_f32 v24, v24, v128
    v_exp_f32 v129, v129
    s_waitcnt lgkmcnt(3)
    v_mfma_f32_32x32x16_bf16 v[100:115], v[28:31], v[80:83], v[100:115]
    ds_read_b128 v[48:51], v11 offset:8192
    v_add_f32 v25, v25, v129
    v_exp_f32 v26, v130
    v_cvt_pk_bf16_f32 v146, v128, v129
    v_mfma_f32_32x32x16_bf16 v[196:211], v[32:35], v[136:139], v[196:211]
    ds_read_b128 v[28:31], v12 offset:8192
    v_add_f32 v24, v24, v26
    v_exp_f32 v27, v131
    s_nop 0
    v_cvt_pk_bf16_f32 v147, v26, v27
    v_add_f32 v25, v25, v27
    s_waitcnt lgkmcnt(3)
    v_mfma_f32_32x32x16_bf16 v[116:131], v[36:39], v[52:55], v[84:99]
    ds_read_b128 v[32:35], v13 offset:8192
    v_exp_f32 v100, v100
    v_exp_f32 v101, v101
    v_mfma_f32_32x32x16_bf16 v[116:131], v[40:43], v[56:59], v[116:131]
    ds_read_b128 v[36:39], v14 offset:8192
    v_exp_f32 v102, v102
    v_exp_f32 v103, v103
    v_cvt_pk_bf16_f32 v132, v100, v101
    v_add_f32 v24, v24, v100
    v_add_f32 v25, v25, v101
    s_waitcnt lgkmcnt(3)
    v_mfma_f32_32x32x16_bf16 v[116:131], v[44:47], v[60:63], v[116:131]
    ds_read_b128 v[40:43], v15 offset:8192
    v_exp_f32 v104, v104
    v_exp_f32 v105, v105
    v_cvt_pk_bf16_f32 v133, v102, v103
    v_add_f32 v24, v24, v102
    v_add_f32 v25, v25, v103
    v_mfma_f32_32x32x16_bf16 v[116:131], v[48:51], v[64:67], v[116:131]
    ds_read_b64_tr_b16 v[44:45], v16 offset:40960
    ds_read_b64_tr_b16 v[46:47], v16 offset:43008
    v_exp_f32 v106, v106
    v_exp_f32 v107, v107
    v_cvt_pk_bf16_f32 v134, v104, v105
    v_add_f32 v24, v24, v104
    v_add_f32 v25, v25, v105
    s_waitcnt lgkmcnt(4)
    v_mfma_f32_32x32x16_bf16 v[116:131], v[28:31], v[68:71], v[116:131]
    ds_read_b64_tr_b16 v[48:49], v16 offset:45056
    ds_read_b64_tr_b16 v[50:51], v16 offset:47104
    v_exp_f32 v108, v108
    v_exp_f32 v109, v109
    v_cvt_pk_bf16_f32 v135, v106, v107
    v_add_f32 v24, v24, v106
    v_add_f32 v25, v25, v107
    v_mfma_f32_32x32x16_bf16 v[116:131], v[32:35], v[72:75], v[116:131]
    ds_read_b64_tr_b16 v[28:29], v17 offset:40960
    ds_read_b64_tr_b16 v[30:31], v17 offset:43008
    v_exp_f32 v110, v110
    v_exp_f32 v111, v111
    v_cvt_pk_bf16_f32 v136, v108, v109
    v_add_f32 v24, v24, v108
    v_add_f32 v25, v25, v109
    s_waitcnt lgkmcnt(6)
    v_mfma_f32_32x32x16_bf16 v[116:131], v[36:39], v[76:79], v[116:131]
    ds_read_b64_tr_b16 v[32:33], v17 offset:45056
    ds_read_b64_tr_b16 v[34:35], v17 offset:47104
    v_exp_f32 v112, v112
    v_exp_f32 v113, v113
    v_cvt_pk_bf16_f32 v137, v110, v111
    v_add_f32 v24, v24, v110
    v_add_f32 v25, v25, v111
    v_mfma_f32_32x32x16_bf16 v[116:131], v[40:43], v[80:83], v[116:131]
    ds_read_b64_tr_b16 v[36:37], v18 offset:40960
    ds_read_b64_tr_b16 v[38:39], v18 offset:43008
    v_exp_f32 v26, v114
    v_exp_f32 v27, v115
    v_cvt_pk_bf16_f32 v138, v112, v113
    v_add_f32 v24, v24, v112
    v_add_f32 v25, v25, v113
    s_waitcnt lgkmcnt(6)
    v_mfma_f32_32x32x16_bf16 v[148:163], v[44:47], v[140:143], v[148:163]
    ds_read_b64_tr_b16 v[40:41], v18 offset:45056
    ds_read_b64_tr_b16 v[42:43], v18 offset:47104
    v_cvt_pk_bf16_f32 v139, v26, v27
    v_add_f32 v24, v24, v26
    v_add_f32 v25, v25, v27
    v_mfma_f32_32x32x16_bf16 v[148:163], v[48:51], v[144:147], v[148:163]
    ds_read_b64_tr_b16 v[44:45], v19 offset:40960
    ds_read_b64_tr_b16 v[46:47], v19 offset:43008
    v_exp_f32 v116, v116
    v_exp_f32 v117, v117
    s_waitcnt lgkmcnt(6)
    v_mfma_f32_32x32x16_bf16 v[164:179], v[28:31], v[140:143], v[164:179]
    ds_read_b64_tr_b16 v[48:49], v19 offset:45056
    ds_read_b64_tr_b16 v[50:51], v19 offset:47104
    v_exp_f32 v118, v118
    v_exp_f32 v119, v119
    v_cvt_pk_bf16_f32 v244, v116, v117
    v_add_f32 v24, v24, v116
    v_add_f32 v25, v25, v117
    v_mfma_f32_32x32x16_bf16 v[164:179], v[32:35], v[144:147], v[164:179]
    s_barrier
    ds_read_b64_tr_b16 v[28:29], v16 offset:49152
    ds_read_b64_tr_b16 v[30:31], v16 offset:51200
    v_exp_f32 v120, v120
    v_exp_f32 v121, v121
    v_cvt_pk_bf16_f32 v245, v118, v119
    v_add_f32 v24, v24, v118
    v_add_f32 v25, v25, v119
    s_waitcnt lgkmcnt(6)
    v_mfma_f32_32x32x16_bf16 v[180:195], v[36:39], v[140:143], v[180:195]
    ds_read_b64_tr_b16 v[32:33], v16 offset:53248
    ds_read_b64_tr_b16 v[34:35], v16 offset:55296
    v_exp_f32 v122, v122
    v_exp_f32 v123, v123
    v_cvt_pk_bf16_f32 v246, v120, v121
    v_add_f32 v24, v24, v120
    v_add_f32 v25, v25, v121
    v_mfma_f32_32x32x16_bf16 v[180:195], v[40:43], v[144:147], v[180:195]
    ds_read_b64_tr_b16 v[36:37], v16 offset:57344
    ds_read_b64_tr_b16 v[38:39], v16 offset:59392
    v_exp_f32 v124, v124
    v_exp_f32 v125, v125
    v_cvt_pk_bf16_f32 v247, v122, v123
    v_add_f32 v24, v24, v122
    v_add_f32 v25, v25, v123
    s_waitcnt lgkmcnt(6)
    v_mfma_f32_32x32x16_bf16 v[196:211], v[44:47], v[140:143], v[196:211]
    ds_read_b64_tr_b16 v[40:41], v16 offset:61440
    ds_read_b64_tr_b16 v[42:43], v16 offset:63488
    v_exp_f32 v126, v126
    v_exp_f32 v127, v127
    v_cvt_pk_bf16_f32 v248, v124, v125
    v_add_f32 v24, v24, v124
    v_add_f32 v25, v25, v125
    v_mfma_f32_32x32x16_bf16 v[196:211], v[48:51], v[144:147], v[196:211]
    ds_read_b64_tr_b16 v[44:45], v17 offset:49152
    ds_read_b64_tr_b16 v[46:47], v17 offset:51200
    v_exp_f32 v128, v128
    v_exp_f32 v129, v129
    v_cvt_pk_bf16_f32 v249, v126, v127
    v_add_f32 v24, v24, v126
    v_add_f32 v25, v25, v127
    s_waitcnt lgkmcnt(6)
    v_mfma_f32_32x32x16_bf16 v[148:163], v[28:31], v[132:135], v[148:163]
    ds_read_b64_tr_b16 v[48:49], v17 offset:53248
    ds_read_b64_tr_b16 v[50:51], v17 offset:55296
    v_exp_f32 v26, v130
    v_exp_f32 v27, v131
    v_cvt_pk_bf16_f32 v250, v128, v129
    v_add_f32 v24, v24, v128
    v_add_f32 v25, v25, v129
    v_mfma_f32_32x32x16_bf16 v[148:163], v[32:35], v[136:139], v[148:163]
    ds_read_b64_tr_b16 v[28:29], v17 offset:57344
    ds_read_b64_tr_b16 v[30:31], v17 offset:59392
    v_cvt_pk_bf16_f32 v251, v26, v27
    v_add_f32 v24, v24, v26
    v_add_f32 v25, v25, v27
    s_waitcnt lgkmcnt(6)
    v_mfma_f32_32x32x16_bf16 v[148:163], v[36:39], v[244:247], v[148:163]
    ds_read_b64_tr_b16 v[32:33], v17 offset:61440
    ds_read_b64_tr_b16 v[34:35], v17 offset:63488
    v_add_f32 v24, v24, v25
    v_mov_b32 v25, v24
    s_nop 1
    v_permlane32_swap_b32 v24, v25
    v_add_f32 v24, v24, v25
    v_cmp_ngt_f32 vcc, 0x4b800000, v24
    v_rcp_f32 v24, v24
    s_cbranch_vccnz L_slow
    v_mfma_f32_32x32x16_bf16 v[148:163], v[40:43], v[248:251], v[148:163]
    ds_read_b64_tr_b16 v[36:37], v18 offset:49152
    ds_read_b64_tr_b16 v[38:39], v18 offset:51200
    v_lshrrev_b32 v1, 2, v0
    v_mul_u32_u24 v1, 288, v1
    v_and_b32 v2, 3, v0
    v_lshl_add_u32 v8, v2, 3, v1
    v_add_u32 v9, 55296, v8
    s_waitcnt lgkmcnt(6)
    v_mfma_f32_32x32x16_bf16 v[164:179], v[44:47], v[132:135], v[164:179]
    ds_read_b64_tr_b16 v[40:41], v18 offset:53248
    ds_read_b64_tr_b16 v[42:43], v18 offset:55296
    v_lshlrev_b32 v12, 4, v0
    s_lshl_b32 s3, s25, 13
    v_add_u32 v12, s3, v12
    s_lshl2_add_u32 s3, s27, s24
    s_lshl_b32 s64, s3, 15
    s_add_u32 s65, s64, 4096
    v_add_u32 v10, 110592, v8
    v_lshlrev_b32 v14, 3, v2
    v_mfma_f32_32x32x16_bf16 v[164:179], v[48:51], v[136:139], v[164:179]
    ds_read_b64_tr_b16 v[44:45], v18 offset:57344
    ds_read_b64_tr_b16 v[46:47], v18 offset:59392
    v_mul_f32 v148, v148, v24
    v_mul_f32 v149, v149, v24
    v_mul_f32 v150, v150, v24
    v_mul_f32 v151, v151, v24
    v_mul_f32 v152, v152, v24
    v_mul_f32 v153, v153, v24
    v_mul_f32 v154, v154, v24
    s_waitcnt lgkmcnt(6)
    v_mfma_f32_32x32x16_bf16 v[164:179], v[28:31], v[244:247], v[164:179]
    ds_read_b64_tr_b16 v[48:49], v18 offset:61440
    ds_read_b64_tr_b16 v[50:51], v18 offset:63488
    v_mul_f32 v155, v155, v24
    v_cvt_pk_bf16_f32 v52, v148, v149
    v_cvt_pk_bf16_f32 v53, v150, v151
L_t6:
    s_cmp_eq_u32 s100, 1
    s_cbranch_scc1 L_wc
    v_cvt_pk_bf16_f32 v54, v152, v153
    v_cvt_pk_bf16_f32 v55, v154, v155
    v_mul_f32 v156, v156, v24
    v_mul_f32 v157, v157, v24
    v_mfma_f32_32x32x16_bf16 v[164:179], v[32:35], v[248:251], v[164:179]
    ds_read_b64_tr_b16 v[28:29], v19 offset:49152
    ds_read_b64_tr_b16 v[30:31], v19 offset:51200
    v_mul_f32 v158, v158, v24
    v_mul_f32 v159, v159, v24
    v_mul_f32 v160, v160, v24
    v_mul_f32 v161, v161, v24
    v_mul_f32 v162, v162, v24
    v_mul_f32 v163, v163, v24
    v_cvt_pk_bf16_f32 v56, v156, v157
    s_waitcnt lgkmcnt(6)
    v_mfma_f32_32x32x16_bf16 v[180:195], v[36:39], v[132:135], v[180:195]
    ds_read_b64_tr_b16 v[32:33], v19 offset:53248
    ds_read_b64_tr_b16 v[34:35], v19 offset:55296
    v_cvt_pk_bf16_f32 v57, v158, v159
    v_cvt_pk_bf16_f32 v58, v160, v161
    v_cvt_pk_bf16_f32 v59, v162, v163
    v_permlane16_swap_b32 v52, v56
    v_permlane16_swap_b32 v53, v57
    v_permlane16_swap_b32 v54, v58
    v_permlane16_swap_b32 v55, v59
    v_mfma_f32_32x32x16_bf16 v[180:195], v[40:43], v[136:139], v[180:195]
    ds_read_b64_tr_b16 v[36:37], v19 offset:57344
    ds_read_b64_tr_b16 v[38:39], v19 offset:59392
    buffer_store_dwordx4 v[52:55], v12, s[48:51], s64 offen offset:0
    buffer_store_dwordx4 v[56:59], v12, s[48:51], s64 offen offset:1024
    v_mul_f32 v164, v164, v24
    v_mul_f32 v165, v165, v24
    v_mul_f32 v166, v166, v24
    v_mul_f32 v167, v167, v24
    v_mul_f32 v168, v168, v24
    s_waitcnt lgkmcnt(6)
    v_mfma_f32_32x32x16_bf16 v[180:195], v[44:47], v[244:247], v[180:195]
    ds_read_b64_tr_b16 v[40:41], v19 offset:61440
    ds_read_b64_tr_b16 v[42:43], v19 offset:63488
    v_mul_f32 v169, v169, v24
    v_mul_f32 v170, v170, v24
    v_mul_f32 v171, v171, v24
    v_cvt_pk_bf16_f32 v60, v164, v165
    v_cvt_pk_bf16_f32 v61, v166, v167
    v_cvt_pk_bf16_f32 v62, v168, v169
    v_cvt_pk_bf16_f32 v63, v170, v171
    v_mfma_f32_32x32x16_bf16 v[180:195], v[48:51], v[248:251], v[180:195]
    v_mul_f32 v172, v172, v24
    v_mul_f32 v173, v173, v24
    v_mul_f32 v174, v174, v24
    v_mul_f32 v175, v175, v24
    v_mul_f32 v176, v176, v24
    v_mul_f32 v177, v177, v24
    v_mul_f32 v178, v178, v24
    s_waitcnt lgkmcnt(4)
    v_mfma_f32_32x32x16_bf16 v[196:211], v[28:31], v[132:135], v[196:211]
    v_mul_f32 v179, v179, v24
    v_cvt_pk_bf16_f32 v64, v172, v173
    v_cvt_pk_bf16_f32 v65, v174, v175
    v_cvt_pk_bf16_f32 v66, v176, v177
    v_cvt_pk_bf16_f32 v67, v178, v179
    v_permlane16_swap_b32 v60, v64
    v_permlane16_swap_b32 v61, v65
    v_mfma_f32_32x32x16_bf16 v[196:211], v[32:35], v[136:139], v[196:211]
    v_permlane16_swap_b32 v62, v66
    v_permlane16_swap_b32 v63, v67
    buffer_store_dwordx4 v[60:63], v12, s[48:51], s64 offen offset:2048
    buffer_store_dwordx4 v[64:67], v12, s[48:51], s64 offen offset:3072
    v_mul_f32 v180, v180, v24
    v_mul_f32 v181, v181, v24
    v_mul_f32 v182, v182, v24
    s_waitcnt lgkmcnt(0)
    v_mfma_f32_32x32x16_bf16 v[196:211], v[36:39], v[244:247], v[196:211]
    v_mul_f32 v183, v183, v24
    v_mul_f32 v184, v184, v24
    v_mul_f32 v185, v185, v24
    v_mul_f32 v186, v186, v24
    v_mul_f32 v187, v187, v24
    v_cvt_pk_bf16_f32 v68, v180, v181
    v_cvt_pk_bf16_f32 v69, v182, v183
    v_mfma_f32_32x32x16_bf16 v[196:211], v[40:43], v[248:251], v[196:211]
    v_cvt_pk_bf16_f32 v70, v184, v185
    v_cvt_pk_bf16_f32 v71, v186, v187
    v_mul_f32 v188, v188, v24
    v_mul_f32 v189, v189, v24
    v_mul_f32 v190, v190, v24
    v_mul_f32 v191, v191, v24
    v_mul_f32 v192, v192, v24
    v_mul_f32 v193, v193, v24
    v_mul_f32 v194, v194, v24
    v_mul_f32 v195, v195, v24
    v_cvt_pk_bf16_f32 v72, v188, v189
    v_cvt_pk_bf16_f32 v73, v190, v191
    v_cvt_pk_bf16_f32 v74, v192, v193
    v_cvt_pk_bf16_f32 v75, v194, v195
    v_permlane16_swap_b32 v68, v72
    v_permlane16_swap_b32 v69, v73
    v_permlane16_swap_b32 v70, v74
    v_permlane16_swap_b32 v71, v75
    buffer_store_dwordx4 v[68:71], v12, s[48:51], s65 offen offset:0
    buffer_store_dwordx4 v[72:75], v12, s[48:51], s65 offen offset:1024
    v_pk_mul_f32 v[196:197], v[196:197], v[24:25] op_sel_hi:[1,0]
    v_pk_mul_f32 v[198:199], v[198:199], v[24:25] op_sel_hi:[1,0]
    v_pk_mul_f32 v[200:201], v[200:201], v[24:25] op_sel_hi:[1,0]
    v_pk_mul_f32 v[202:203], v[202:203], v[24:25] op_sel_hi:[1,0]
    v_cvt_pk_bf16_f32 v76, v196, v197
    v_cvt_pk_bf16_f32 v77, v198, v199
    v_cvt_pk_bf16_f32 v78, v200, v201
    v_cvt_pk_bf16_f32 v79, v202, v203
    v_pk_mul_f32 v[204:205], v[204:205], v[24:25] op_sel_hi:[1,0]
    v_pk_mul_f32 v[206:207], v[206:207], v[24:25] op_sel_hi:[1,0]
    v_pk_mul_f32 v[208:209], v[208:209], v[24:25] op_sel_hi:[1,0]
    v_pk_mul_f32 v[210:211], v[210:211], v[24:25] op_sel_hi:[1,0]
    v_cvt_pk_bf16_f32 v80, v204, v205
    v_cvt_pk_bf16_f32 v81, v206, v207
    v_cvt_pk_bf16_f32 v82, v208, v209
    v_cvt_pk_bf16_f32 v83, v210, v211
    v_permlane16_swap_b32 v76, v80
    v_permlane16_swap_b32 v77, v81
    v_permlane16_swap_b32 v78, v82
    v_permlane16_swap_b32 v79, v83
    buffer_store_dwordx4 v[76:79], v12, s[48:51], s65 offen offset:2048
    buffer_store_dwordx4 v[80:83], v12, s[48:51], s65 offen offset:3072
L_p2:
    s_waitcnt lgkmcnt(0)
    s_barrier
    ds_read_b64_tr_b16 v[28:29], v9 offset:0
    ds_read_b64_tr_b16 v[30:31], v9 offset:4608
    ds_read_b64_tr_b16 v[32:33], v9 offset:32
    ds_read_b64_tr_b16 v[34:35], v9 offset:4640
    ds_read_b64_tr_b16 v[36:37], v9 offset:64
    ds_read_b64_tr_b16 v[38:39], v9 offset:4672
    ds_read_b64_tr_b16 v[40:41], v9 offset:96
    ds_read_b64_tr_b16 v[42:43], v9 offset:4704
    s_waitcnt lgkmcnt(6)
    v_mfma_f32_16x16x32_bf16 v[84:87], v[28:31], v[52:55], 0
    ds_read_b64_tr_b16 v[44:45], v9 offset:128
    s_mov_b32 s95, 1
    s_cmp_eq_u64 s[4:5], s[98:99]
    s_cselect_b32 s95, s95, 0
    v_mfma_f32_16x16x32_bf16 v[120:123], v[28:31], v[56:59], 0
    ds_read_b64_tr_b16 v[46:47], v9 offset:4736
    s_cmp_eq_u64 s[6:7], s[98:99]
    s_cselect_b32 s95, s95, 0
    s_cmp_eq_u64 s[8:9], s[98:99]
    s_cselect_b32 s95, s95, 0
    s_waitcnt lgkmcnt(6)
    v_mfma_f32_16x16x32_bf16 v[88:91], v[32:35], v[52:55], 0
    ds_read_b64_tr_b16 v[28:29], v9 offset:160
    s_cmp_eq_u64 s[10:11], s[98:99]
    s_cselect_b32 s95, s95, 0
    s_lshl2_add_u32 s3, s27, s25
    v_mfma_f32_16x16x32_bf16 v[124:127], v[32:35], v[56:59], 0
    ds_read_b64_tr_b16 v[30:31], v9 offset:4768
    s_lshl_b32 s3, s3, 7
    s_add_u32 s28, s3, 33554432
    s_waitcnt lgkmcnt(6)
    v_mfma_f32_16x16x32_bf16 v[92:95], v[36:39], v[52:55], 0
    ds_read_b64_tr_b16 v[32:33], v9 offset:192
    s_lshl3_add_u32 s29, s24, s28
    s_lshl2_add_u32 s3, s21, s25
    v_mfma_f32_16x16x32_bf16 v[128:131], v[36:39], v[56:59], 0
    ds_read_b64_tr_b16 v[34:35], v9 offset:4800
    s_lshl3_add_u32 s30, s3, s24
    s_lshl3_add_u32 s30, s30, s23
    s_waitcnt lgkmcnt(6)
    v_mfma_f32_16x16x32_bf16 v[96:99], v[40:43], v[52:55], 0
    ds_read_b64_tr_b16 v[36:37], v9 offset:224
    s_mul_i32 s30, s30, 4608
    s_lshl2_add_u32 s3, s3, s24
    v_mfma_f32_16x16x32_bf16 v[132:135], v[40:43], v[56:59], 0
    ds_read_b64_tr_b16 v[38:39], v9 offset:4832
    s_lshl_b32 s3, s3, 10
    s_lshl3_add_u32 s3, s23, s3
    s_waitcnt lgkmcnt(6)
    v_mfma_f32_16x16x32_bf16 v[100:103], v[44:47], v[52:55], 0
    ds_read_b64_tr_b16 v[40:41], v9 offset:256
    s_add_u32 s31, s3, 34603008
    v_lshlrev_b32 v13, 4, v0
    v_mfma_f32_16x16x32_bf16 v[136:139], v[44:47], v[56:59], 0
    ds_read_b64_tr_b16 v[42:43], v9 offset:4864
    v_lshlrev_b32 v15, 3, v0
    s_waitcnt lgkmcnt(6)
    v_mfma_f32_16x16x32_bf16 v[104:107], v[28:31], v[52:55], 0
    ds_read_b64_tr_b16 v[44:45], v9 offset:9216
    v_mfma_f32_16x16x32_bf16 v[140:143], v[28:31], v[56:59], 0
    ds_read_b64_tr_b16 v[46:47], v9 offset:13824
    s_waitcnt lgkmcnt(6)
    v_mfma_f32_16x16x32_bf16 v[108:111], v[32:35], v[52:55], 0
    ds_read_b64_tr_b16 v[28:29], v9 offset:9248
    v_mfma_f32_16x16x32_bf16 v[144:147], v[32:35], v[56:59], 0
    ds_read_b64_tr_b16 v[30:31], v9 offset:13856
    s_waitcnt lgkmcnt(6)
    v_mfma_f32_16x16x32_bf16 v[112:115], v[36:39], v[52:55], 0
    ds_read_b64_tr_b16 v[32:33], v9 offset:9280
    v_mfma_f32_16x16x32_bf16 v[148:151], v[36:39], v[56:59], 0
    ds_read_b64_tr_b16 v[34:35], v9 offset:13888
    s_waitcnt lgkmcnt(6)
    v_mfma_f32_16x16x32_bf16 v[116:119], v[40:43], v[52:55], 0
    ds_read_b64_tr_b16 v[36:37], v9 offset:9312
    v_mfma_f32_16x16x32_bf16 v[152:155], v[40:43], v[56:59], 0
    ds_read_b64_tr_b16 v[38:39], v9 offset:13920
    s_waitcnt lgkmcnt(6)
    v_mfma_f32_16x16x32_bf16 v[84:87], v[44:47], v[60:63], v[84:87]
    ds_read_b64_tr_b16 v[40:41], v9 offset:9344
    v_mfma_f32_16x16x32_bf16 v[120:123], v[44:47], v[64:67], v[120:123]
    ds_read_b64_tr_b16 v[42:43], v9 offset:13952
    s_waitcnt lgkmcnt(6)
    v_mfma_f32_16x16x32_bf16 v[88:91], v[28:31], v[60:63], v[88:91]
    ds_read_b64_tr_b16 v[44:45], v9 offset:9376
    s_waitcnt vmcnt(0)
    s_cmp_eq_u32 s95, 0
    s_cbranch_scc1 L_far
    s_mov_b64 exec, 1
    buffer_store_dwordx2 v[252:253], off, s[48:51], s29
L_near:
    s_mov_b64 exec, -1
    v_mfma_f32_16x16x32_bf16 v[124:127], v[28:31], v[64:67], v[124:127]
    ds_read_b64_tr_b16 v[46:47], v9 offset:13984
    s_add_u32 s3, s24, 1
    s_and_b32 s3, s3, 3
    s_lshl2_add_u32 s3, s27, s3
    s_lshl_b32 s64, s3, 15
    s_add_u32 s65, s64, 4096
    s_waitcnt lgkmcnt(6)
    v_mfma_f32_16x16x32_bf16 v[92:95], v[32:35], v[60:63], v[92:95]
    ds_read_b64_tr_b16 v[28:29], v9 offset:9408
    s_add_u32 s3, s24, 2
    s_and_b32 s3, s3, 3
    s_lshl2_add_u32 s3, s27, s3
    s_lshl_b32 s66, s3, 15
    s_add_u32 s67, s66, 4096
    v_mfma_f32_16x16x32_bf16 v[128:131], v[32:35], v[64:67], v[128:131]
    ds_read_b64_tr_b16 v[30:31], v9 offset:14016
    s_add_u32 s3, s24, 3
    s_and_b32 s3, s3, 3
    s_lshl2_add_u32 s3, s27, s3
    s_lshl_b32 s68, s3, 15
    s_add_u32 s69, s68, 4096
    s_waitcnt lgkmcnt(6)
    v_mfma_f32_16x16x32_bf16 v[96:99], v[36:39], v[60:63], v[96:99]
    ds_read_b64_tr_b16 v[32:33], v9 offset:9440
    v_mfma_f32_16x16x32_bf16 v[132:135], v[36:39], v[64:67], v[132:135]
    ds_read_b64_tr_b16 v[34:35], v9 offset:14048
    s_waitcnt lgkmcnt(6)
    v_mfma_f32_16x16x32_bf16 v[100:103], v[40:43], v[60:63], v[100:103]
    ds_read_b64_tr_b16 v[36:37], v9 offset:9472
    v_mfma_f32_16x16x32_bf16 v[136:139], v[40:43], v[64:67], v[136:139]
    ds_read_b64_tr_b16 v[38:39], v9 offset:14080
    s_waitcnt lgkmcnt(6)
    v_mfma_f32_16x16x32_bf16 v[104:107], v[44:47], v[60:63], v[104:107]
    ds_read_b64_tr_b16 v[40:41], v9 offset:18432
    v_mfma_f32_16x16x32_bf16 v[140:143], v[44:47], v[64:67], v[140:143]
    ds_read_b64_tr_b16 v[42:43], v9 offset:23040
    s_waitcnt lgkmcnt(6)
    v_mfma_f32_16x16x32_bf16 v[108:111], v[28:31], v[60:63], v[108:111]
    ds_read_b64_tr_b16 v[44:45], v9 offset:18464
    buffer_load_dwordx2 v[2:3], v14, s[48:51], s28 offen sc1
    v_mfma_f32_16x16x32_bf16 v[144:147], v[28:31], v[64:67], v[144:147]
    ds_read_b64_tr_b16 v[46:47], v9 offset:23072
    s_waitcnt lgkmcnt(6)
    v_mfma_f32_16x16x32_bf16 v[112:115], v[32:35], v[60:63], v[112:115]
    ds_read_b64_tr_b16 v[28:29], v9 offset:18496
    v_mfma_f32_16x16x32_bf16 v[148:151], v[32:35], v[64:67], v[148:151]
    ds_read_b64_tr_b16 v[30:31], v9 offset:23104
    s_waitcnt lgkmcnt(6)
    v_mfma_f32_16x16x32_bf16 v[116:119], v[36:39], v[60:63], v[116:119]
    ds_read_b64_tr_b16 v[32:33], v9 offset:18528
    v_mfma_f32_16x16x32_bf16 v[152:155], v[36:39], v[64:67], v[152:155]
    ds_read_b64_tr_b16 v[34:35], v9 offset:23136
    s_waitcnt lgkmcnt(6)
    v_mfma_f32_16x16x32_bf16 v[84:87], v[40:43], v[68:71], v[84:87]
    ds_read_b64_tr_b16 v[36:37], v9 offset:18560
    v_mfma_f32_16x16x32_bf16 v[120:123], v[40:43], v[72:75], v[120:123]
    ds_read_b64_tr_b16 v[38:39], v9 offset:23168
    s_waitcnt lgkmcnt(6)
    v_mfma_f32_16x16x32_bf16 v[88:91], v[44:47], v[68:71], v[88:91]
    ds_read_b64_tr_b16 v[40:41], v9 offset:18592
    v_mfma_f32_16x16x32_bf16 v[124:127], v[44:47], v[72:75], v[124:127]
    ds_read_b64_tr_b16 v[42:43], v9 offset:23200
    s_waitcnt lgkmcnt(6)
    v_mfma_f32_16x16x32_bf16 v[92:95], v[28:31], v[68:71], v[92:95]
    ds_read_b64_tr_b16 v[44:45], v9 offset:18624
    v_mfma_f32_16x16x32_bf16 v[128:131], v[28:31], v[72:75], v[128:131]
    ds_read_b64_tr_b16 v[46:47], v9 offset:23232
    s_waitcnt lgkmcnt(6)
    v_mfma_f32_16x16x32_bf16 v[96:99], v[32:35], v[68:71], v[96:99]
    ds_read_b64_tr_b16 v[28:29], v9 offset:18656
    v_mfma_f32_16x16x32_bf16 v[132:135], v[32:35], v[72:75], v[132:135]
    ds_read_b64_tr_b16 v[30:31], v9 offset:23264
    s_waitcnt lgkmcnt(6)
    v_mfma_f32_16x16x32_bf16 v[100:103], v[36:39], v[68:71], v[100:103]
    ds_read_b64_tr_b16 v[32:33], v9 offset:18688
    v_mfma_f32_16x16x32_bf16 v[136:139], v[36:39], v[72:75], v[136:139]
    ds_read_b64_tr_b16 v[34:35], v9 offset:23296
    s_waitcnt lgkmcnt(6)
    v_mfma_f32_16x16x32_bf16 v[104:107], v[40:43], v[68:71], v[104:107]
    ds_read_b64_tr_b16 v[36:37], v9 offset:27648
    v_mfma_f32_16x16x32_bf16 v[140:143], v[40:43], v[72:75], v[140:143]
    ds_read_b64_tr_b16 v[38:39], v9 offset:32256
    s_waitcnt lgkmcnt(6)
    v_mfma_f32_16x16x32_bf16 v[108:111], v[44:47], v[68:71], v[108:111]
    ds_read_b64_tr_b16 v[40:41], v9 offset:27680
    v_mfma_f32_16x16x32_bf16 v[144:147], v[44:47], v[72:75], v[144:147]
    ds_read_b64_tr_b16 v[42:43], v9 offset:32288
    s_waitcnt lgkmcnt(6)
    v_mfma_f32_16x16x32_bf16 v[112:115], v[28:31], v[68:71], v[112:115]
    ds_read_b64_tr_b16 v[44:45], v9 offset:27712
    v_mfma_f32_16x16x32_bf16 v[148:151], v[28:31], v[72:75], v[148:151]
    ds_read_b64_tr_b16 v[46:47], v9 offset:32320
    s_waitcnt lgkmcnt(6)
    v_mfma_f32_16x16x32_bf16 v[116:119], v[32:35], v[68:71], v[116:119]
    ds_read_b64_tr_b16 v[28:29], v9 offset:27744
    v_mfma_f32_16x16x32_bf16 v[152:155], v[32:35], v[72:75], v[152:155]
    ds_read_b64_tr_b16 v[30:31], v9 offset:32352
    s_waitcnt lgkmcnt(6)
    v_mfma_f32_16x16x32_bf16 v[84:87], v[36:39], v[76:79], v[84:87]
    ds_read_b64_tr_b16 v[32:33], v9 offset:27776
    v_mfma_f32_16x16x32_bf16 v[120:123], v[36:39], v[80:83], v[120:123]
    ds_read_b64_tr_b16 v[34:35], v9 offset:32384
    s_waitcnt vmcnt(0)
    v_cmp_eq_u64 vcc, v[2:3], v[252:253]
    s_waitcnt lgkmcnt(6)
    v_mfma_f32_16x16x32_bf16 v[88:91], v[40:43], v[76:79], v[88:91]
    ds_read_b64_tr_b16 v[36:37], v9 offset:27808
    s_lshr_b32 s94, vcc_lo, s24
    s_bitcmp1_b32 s94, 1
    s_cbranch_scc0 L_rt1
L_bk1:
    buffer_load_dwordx4 v[156:159], v12, s[48:51], s64 offen offset:0 sc1
    v_mfma_f32_16x16x32_bf16 v[124:127], v[40:43], v[80:83], v[124:127]
    ds_read_b64_tr_b16 v[38:39], v9 offset:32416
    buffer_load_dwordx4 v[160:163], v12, s[48:51], s64 offen offset:1024 sc1
    s_waitcnt lgkmcnt(6)
    v_mfma_f32_16x16x32_bf16 v[92:95], v[44:47], v[76:79], v[92:95]
    ds_read_b64_tr_b16 v[40:41], v9 offset:27840
    buffer_load_dwordx4 v[164:167], v12, s[48:51], s64 offen offset:2048 sc1
    v_mfma_f32_16x16x32_bf16 v[128:131], v[44:47], v[80:83], v[128:131]
    ds_read_b64_tr_b16 v[42:43], v9 offset:32448
    buffer_load_dwordx4 v[168:171], v12, s[48:51], s64 offen offset:3072 sc1
    s_waitcnt lgkmcnt(6)
    v_mfma_f32_16x16x32_bf16 v[96:99], v[28:31], v[76:79], v[96:99]
    ds_read_b64_tr_b16 v[44:45], v9 offset:27872
    buffer_load_dwordx4 v[172:175], v12, s[48:51], s65 offen offset:0 sc1
    v_mfma_f32_16x16x32_bf16 v[132:135], v[28:31], v[80:83], v[132:135]
    ds_read_b64_tr_b16 v[46:47], v9 offset:32480
    buffer_load_dwordx4 v[176:179], v12, s[48:51], s65 offen offset:1024 sc1
    s_waitcnt lgkmcnt(6)
    v_mfma_f32_16x16x32_bf16 v[100:103], v[32:35], v[76:79], v[100:103]
    ds_read_b64_tr_b16 v[28:29], v9 offset:27904
    buffer_load_dwordx4 v[180:183], v12, s[48:51], s65 offen offset:2048 sc1
    buffer_load_dwordx2 v[2:3], v14, s[48:51], s28 offen sc1
    v_mfma_f32_16x16x32_bf16 v[136:139], v[32:35], v[80:83], v[136:139]
    ds_read_b64_tr_b16 v[30:31], v9 offset:32512
    buffer_load_dwordx4 v[184:187], v12, s[48:51], s65 offen offset:3072 sc1
    s_waitcnt lgkmcnt(6)
    v_mfma_f32_16x16x32_bf16 v[104:107], v[36:39], v[76:79], v[104:107]
    ds_read_b64_tr_b16 v[32:33], v8 offset:36864
    v_mfma_f32_16x16x32_bf16 v[140:143], v[36:39], v[80:83], v[140:143]
    ds_read_b64_tr_b16 v[34:35], v8 offset:41472
    s_waitcnt lgkmcnt(6)
    v_mfma_f32_16x16x32_bf16 v[108:111], v[40:43], v[76:79], v[108:111]
    ds_read_b64_tr_b16 v[36:37], v8 offset:36896
    v_mfma_f32_16x16x32_bf16 v[144:147], v[40:43], v[80:83], v[144:147]
    ds_read_b64_tr_b16 v[38:39], v8 offset:41504
    s_waitcnt lgkmcnt(6)
    v_mfma_f32_16x16x32_bf16 v[112:115], v[44:47], v[76:79], v[112:115]
    ds_read_b64_tr_b16 v[40:41], v8 offset:36928
    v_mfma_f32_16x16x32_bf16 v[148:151], v[44:47], v[80:83], v[148:151]
    ds_read_b64_tr_b16 v[42:43], v8 offset:41536
    s_waitcnt lgkmcnt(6)
    v_mfma_f32_16x16x32_bf16 v[116:119], v[28:31], v[76:79], v[116:119]
    ds_read_b64_tr_b16 v[44:45], v8 offset:36960
    v_mfma_f32_16x16x32_bf16 v[152:155], v[28:31], v[80:83], v[152:155]
    ds_read_b64_tr_b16 v[46:47], v8 offset:41568
    s_waitcnt vmcnt(7)
    s_waitcnt lgkmcnt(6)
    v_mfma_f32_16x16x32_bf16 v[84:87], v[32:35], v[156:159], v[84:87]
    ds_read_b64_tr_b16 v[28:29], v8 offset:36992
    v_mfma_f32_16x16x32_bf16 v[120:123], v[32:35], v[160:163], v[120:123]
    ds_read_b64_tr_b16 v[30:31], v8 offset:41600
    s_waitcnt lgkmcnt(6)
    v_mfma_f32_16x16x32_bf16 v[88:91], v[36:39], v[156:159], v[88:91]
    ds_read_b64_tr_b16 v[32:33], v8 offset:37024
    v_mfma_f32_16x16x32_bf16 v[124:127], v[36:39], v[160:163], v[124:127]
    ds_read_b64_tr_b16 v[34:35], v8 offset:41632
    s_waitcnt lgkmcnt(6)
    v_mfma_f32_16x16x32_bf16 v[92:95], v[40:43], v[156:159], v[92:95]
    ds_read_b64_tr_b16 v[36:37], v8 offset:37056
    v_mfma_f32_16x16x32_bf16 v[128:131], v[40:43], v[160:163], v[128:131]
    ds_read_b64_tr_b16 v[38:39], v8 offset:41664
    s_waitcnt lgkmcnt(6)
    v_mfma_f32_16x16x32_bf16 v[96:99], v[44:47], v[156:159], v[96:99]
    ds_read_b64_tr_b16 v[40:41], v8 offset:37088
    v_mfma_f32_16x16x32_bf16 v[132:135], v[44:47], v[160:163], v[132:135]
    ds_read_b64_tr_b16 v[42:43], v8 offset:41696
    s_waitcnt lgkmcnt(6)
    v_mfma_f32_16x16x32_bf16 v[100:103], v[28:31], v[156:159], v[100:103]
    ds_read_b64_tr_b16 v[44:45], v8 offset:37120
    v_mfma_f32_16x16x32_bf16 v[136:139], v[28:31], v[160:163], v[136:139]
    ds_read_b64_tr_b16 v[46:47], v8 offset:41728
    s_waitcnt lgkmcnt(6)
    v_mfma_f32_16x16x32_bf16 v[104:107], v[32:35], v[156:159], v[104:107]
    ds_read_b64_tr_b16 v[28:29], v8 offset:46080
    v_mfma_f32_16x16x32_bf16 v[140:143], v[32:35], v[160:163], v[140:143]
    ds_read_b64_tr_b16 v[30:31], v8 offset:50688
    s_waitcnt lgkmcnt(6)
    v_mfma_f32_16x16x32_bf16 v[108:111], v[36:39], v[156:159], v[108:111]
    ds_read_b64_tr_b16 v[32:33], v8 offset:46112
    v_mfma_f32_16x16x32_bf16 v[144:147], v[36:39], v[160:163], v[144:147]
    ds_read_b64_tr_b16 v[34:35], v8 offset:50720
    s_waitcnt lgkmcnt(6)
    v_mfma_f32_16x16x32_bf16 v[112:115], v[40:43], v[156:159], v[112:115]
    ds_read_b64_tr_b16 v[36:37], v8 offset:46144
    v_mfma_f32_16x16x32_bf16 v[148:151], v[40:43], v[160:163], v[148:151]
    ds_read_b64_tr_b16 v[38:39], v8 offset:50752
    s_waitcnt lgkmcnt(6)
    v_mfma_f32_16x16x32_bf16 v[116:119], v[44:47], v[156:159], v[116:119]
    ds_read_b64_tr_b16 v[40:41], v8 offset:46176
    v_mfma_f32_16x16x32_bf16 v[152:155], v[44:47], v[160:163], v[152:155]
    ds_read_b64_tr_b16 v[42:43], v8 offset:50784
    s_waitcnt vmcnt(1)
    v_cmp_eq_u64 vcc, v[2:3], v[252:253]
    s_waitcnt vmcnt(5)
    s_waitcnt lgkmcnt(6)
    v_mfma_f32_16x16x32_bf16 v[84:87], v[28:31], v[164:167], v[84:87]
    ds_read_b64_tr_b16 v[44:45], v8 offset:46208
    s_lshr_b32 s94, vcc_lo, s24
    s_bitcmp1_b32 s94, 2
    s_cbranch_scc0 L_rt2
L_bk2:
    buffer_load_dwordx4 v[188:191], v12, s[48:51], s66 offen offset:0 sc1
    v_mfma_f32_16x16x32_bf16 v[120:123], v[28:31], v[168:171], v[120:123]
    ds_read_b64_tr_b16 v[46:47], v8 offset:50816
    s_waitcnt lgkmcnt(6)
    v_mfma_f32_16x16x32_bf16 v[88:91], v[32:35], v[164:167], v[88:91]
    ds_read_b64_tr_b16 v[28:29], v8 offset:46240
    buffer_load_dwordx4 v[192:195], v12, s[48:51], s66 offen offset:1024 sc1
    v_mfma_f32_16x16x32_bf16 v[124:127], v[32:35], v[168:171], v[124:127]
    ds_read_b64_tr_b16 v[30:31], v8 offset:50848
    s_waitcnt lgkmcnt(6)
    v_mfma_f32_16x16x32_bf16 v[92:95], v[36:39], v[164:167], v[92:95]
    ds_read_b64_tr_b16 v[32:33], v8 offset:46272
    v_mfma_f32_16x16x32_bf16 v[128:131], v[36:39], v[168:171], v[128:131]
    ds_read_b64_tr_b16 v[34:35], v8 offset:50880
    buffer_load_dwordx4 v[196:199], v12, s[48:51], s66 offen offset:2048 sc1
    s_waitcnt lgkmcnt(6)
    v_mfma_f32_16x16x32_bf16 v[96:99], v[40:43], v[164:167], v[96:99]
    ds_read_b64_tr_b16 v[36:37], v8 offset:46304
    v_mfma_f32_16x16x32_bf16 v[132:135], v[40:43], v[168:171], v[132:135]
    ds_read_b64_tr_b16 v[38:39], v8 offset:50912
    buffer_load_dwordx4 v[200:203], v12, s[48:51], s66 offen offset:3072 sc1
    s_waitcnt lgkmcnt(6)
    v_mfma_f32_16x16x32_bf16 v[100:103], v[44:47], v[164:167], v[100:103]
    ds_read_b64_tr_b16 v[40:41], v8 offset:46336
    v_mfma_f32_16x16x32_bf16 v[136:139], v[44:47], v[168:171], v[136:139]
    ds_read_b64_tr_b16 v[42:43], v8 offset:50944
    s_waitcnt lgkmcnt(6)
    v_mfma_f32_16x16x32_bf16 v[104:107], v[28:31], v[164:167], v[104:107]
    ds_read_b64_tr_b16 v[44:45], v9 offset:36864
    buffer_load_dwordx4 v[204:207], v12, s[48:51], s67 offen offset:0 sc1
    v_mfma_f32_16x16x32_bf16 v[140:143], v[28:31], v[168:171], v[140:143]
    ds_read_b64_tr_b16 v[46:47], v9 offset:41472
    s_waitcnt lgkmcnt(6)
    v_mfma_f32_16x16x32_bf16 v[108:111], v[32:35], v[164:167], v[108:111]
    ds_read_b64_tr_b16 v[28:29], v9 offset:36896
    buffer_load_dwordx4 v[208:211], v12, s[48:51], s67 offen offset:1024 sc1
    v_mfma_f32_16x16x32_bf16 v[144:147], v[32:35], v[168:171], v[144:147]
    ds_read_b64_tr_b16 v[30:31], v9 offset:41504
    s_waitcnt lgkmcnt(6)
    v_mfma_f32_16x16x32_bf16 v[112:115], v[36:39], v[164:167], v[112:115]
    ds_read_b64_tr_b16 v[32:33], v9 offset:36928
    v_mfma_f32_16x16x32_bf16 v[148:151], v[36:39], v[168:171], v[148:151]
    ds_read_b64_tr_b16 v[34:35], v9 offset:41536
    buffer_load_dwordx4 v[212:215], v12, s[48:51], s67 offen offset:2048 sc1
    s_waitcnt lgkmcnt(6)
    v_mfma_f32_16x16x32_bf16 v[116:119], v[40:43], v[164:167], v[116:119]
    ds_read_b64_tr_b16 v[36:37], v9 offset:36960
    v_mfma_f32_16x16x32_bf16 v[152:155], v[40:43], v[168:171], v[152:155]
    ds_read_b64_tr_b16 v[38:39], v9 offset:41568
    buffer_load_dwordx4 v[216:219], v12, s[48:51], s67 offen offset:3072 sc1
    s_waitcnt vmcnt(11)
    s_waitcnt lgkmcnt(6)
    v_mfma_f32_16x16x32_bf16 v[84:87], v[44:47], v[172:175], v[84:87]
    ds_read_b64_tr_b16 v[40:41], v9 offset:36992
    v_mfma_f32_16x16x32_bf16 v[120:123], v[44:47], v[176:179], v[120:123]
    ds_read_b64_tr_b16 v[42:43], v9 offset:41600
    s_waitcnt lgkmcnt(6)
    v_mfma_f32_16x16x32_bf16 v[88:91], v[28:31], v[172:175], v[88:91]
    ds_read_b64_tr_b16 v[44:45], v9 offset:37024
    v_mfma_f32_16x16x32_bf16 v[124:127], v[28:31], v[176:179], v[124:127]
    ds_read_b64_tr_b16 v[46:47], v9 offset:41632
    s_waitcnt lgkmcnt(6)
    v_mfma_f32_16x16x32_bf16 v[92:95], v[32:35], v[172:175], v[92:95]
    ds_read_b64_tr_b16 v[28:29], v9 offset:37056
    s_bitcmp1_b32 s94, 3
    s_cbranch_scc0 L_rt3
L_bk3:
    buffer_load_dwordx4 v[220:223], v12, s[48:51], s68 offen offset:0 sc1
    v_mfma_f32_16x16x32_bf16 v[128:131], v[32:35], v[176:179], v[128:131]
    ds_read_b64_tr_b16 v[30:31], v9 offset:41664
    s_waitcnt lgkmcnt(6)
    v_mfma_f32_16x16x32_bf16 v[96:99], v[36:39], v[172:175], v[96:99]
    ds_read_b64_tr_b16 v[32:33], v9 offset:37088
    buffer_load_dwordx4 v[224:227], v12, s[48:51], s68 offen offset:1024 sc1
    v_mfma_f32_16x16x32_bf16 v[132:135], v[36:39], v[176:179], v[132:135]
    ds_read_b64_tr_b16 v[34:35], v9 offset:41696
    s_waitcnt lgkmcnt(6)
    v_mfma_f32_16x16x32_bf16 v[100:103], v[40:43], v[172:175], v[100:103]
    ds_read_b64_tr_b16 v[36:37], v9 offset:37120
    v_mfma_f32_16x16x32_bf16 v[136:139], v[40:43], v[176:179], v[136:139]
    ds_read_b64_tr_b16 v[38:39], v9 offset:41728
    buffer_load_dwordx4 v[228:231], v12, s[48:51], s68 offen offset:2048 sc1
    s_waitcnt lgkmcnt(6)
    v_mfma_f32_16x16x32_bf16 v[104:107], v[44:47], v[172:175], v[104:107]
    ds_read_b64_tr_b16 v[40:41], v9 offset:46080
    v_mfma_f32_16x16x32_bf16 v[140:143], v[44:47], v[176:179], v[140:143]
    ds_read_b64_tr_b16 v[42:43], v9 offset:50688
    buffer_load_dwordx4 v[232:235], v12, s[48:51], s68 offen offset:3072 sc1
    s_waitcnt lgkmcnt(6)
    v_mfma_f32_16x16x32_bf16 v[108:111], v[28:31], v[172:175], v[108:111]
    ds_read_b64_tr_b16 v[44:45], v9 offset:46112
    v_mfma_f32_16x16x32_bf16 v[144:147], v[28:31], v[176:179], v[144:147]
    ds_read_b64_tr_b16 v[46:47], v9 offset:50720
    s_waitcnt lgkmcnt(6)
    v_mfma_f32_16x16x32_bf16 v[112:115], v[32:35], v[172:175], v[112:115]
    ds_read_b64_tr_b16 v[28:29], v9 offset:46144
    buffer_load_dwordx4 v[236:239], v12, s[48:51], s69 offen offset:0 sc1
    v_mfma_f32_16x16x32_bf16 v[148:151], v[32:35], v[176:179], v[148:151]
    ds_read_b64_tr_b16 v[30:31], v9 offset:50752
    s_waitcnt lgkmcnt(6)
    v_mfma_f32_16x16x32_bf16 v[116:119], v[36:39], v[172:175], v[116:119]
    ds_read_b64_tr_b16 v[32:33], v9 offset:46176
    buffer_load_dwordx4 v[240:243], v12, s[48:51], s69 offen offset:1024 sc1
    v_mfma_f32_16x16x32_bf16 v[152:155], v[36:39], v[176:179], v[152:155]
    ds_read_b64_tr_b16 v[34:35], v9 offset:50784
    s_waitcnt vmcnt(14)
    s_waitcnt lgkmcnt(6)
    v_mfma_f32_16x16x32_bf16 v[84:87], v[40:43], v[180:183], v[84:87]
    ds_read_b64_tr_b16 v[36:37], v9 offset:46208
    v_mfma_f32_16x16x32_bf16 v[120:123], v[40:43], v[184:187], v[120:123]
    ds_read_b64_tr_b16 v[38:39], v9 offset:50816
    buffer_load_dwordx4 v[244:247], v12, s[48:51], s69 offen offset:2048 sc1
    s_waitcnt lgkmcnt(6)
    v_mfma_f32_16x16x32_bf16 v[88:91], v[44:47], v[180:183], v[88:91]
    ds_read_b64_tr_b16 v[40:41], v9 offset:46240
    v_mfma_f32_16x16x32_bf16 v[124:127], v[44:47], v[184:187], v[124:127]
    ds_read_b64_tr_b16 v[42:43], v9 offset:50848
    buffer_load_dwordx4 v[248:251], v12, s[48:51], s69 offen offset:3072 sc1
    s_waitcnt lgkmcnt(6)
    v_mfma_f32_16x16x32_bf16 v[92:95], v[28:31], v[180:183], v[92:95]
    ds_read_b64_tr_b16 v[44:45], v9 offset:46272
    v_mfma_f32_16x16x32_bf16 v[128:131], v[28:31], v[184:187], v[128:131]
    ds_read_b64_tr_b16 v[46:47], v9 offset:50880
    s_waitcnt lgkmcnt(6)
    v_mfma_f32_16x16x32_bf16 v[96:99], v[32:35], v[180:183], v[96:99]
    ds_read_b64_tr_b16 v[28:29], v9 offset:46304
    v_mfma_f32_16x16x32_bf16 v[132:135], v[32:35], v[184:187], v[132:135]
    ds_read_b64_tr_b16 v[30:31], v9 offset:50912
    s_waitcnt lgkmcnt(6)
    v_mfma_f32_16x16x32_bf16 v[100:103], v[36:39], v[180:183], v[100:103]
    ds_read_b64_tr_b16 v[32:33], v9 offset:46336
    v_mfma_f32_16x16x32_bf16 v[136:139], v[36:39], v[184:187], v[136:139]
    ds_read_b64_tr_b16 v[34:35], v9 offset:50944
    s_waitcnt lgkmcnt(6)
    v_mfma_f32_16x16x32_bf16 v[104:107], v[40:43], v[180:183], v[104:107]
    s_barrier
    ds_read_b64_tr_b16 v[36:37], v8 offset:18432
    v_mfma_f32_16x16x32_bf16 v[140:143], v[40:43], v[184:187], v[140:143]
    ds_read_b64_tr_b16 v[38:39], v8 offset:23040
    s_waitcnt lgkmcnt(6)
    v_mfma_f32_16x16x32_bf16 v[108:111], v[44:47], v[180:183], v[108:111]
    ds_read_b64_tr_b16 v[40:41], v8 offset:18464
    v_mfma_f32_16x16x32_bf16 v[144:147], v[44:47], v[184:187], v[144:147]
    ds_read_b64_tr_b16 v[42:43], v8 offset:23072
    s_waitcnt lgkmcnt(6)
    v_mfma_f32_16x16x32_bf16 v[112:115], v[28:31], v[180:183], v[112:115]
    ds_read_b64_tr_b16 v[44:45], v8 offset:27648
    v_mfma_f32_16x16x32_bf16 v[148:151], v[28:31], v[184:187], v[148:151]
    ds_read_b64_tr_b16 v[46:47], v8 offset:32256
    s_waitcnt lgkmcnt(6)
    v_mfma_f32_16x16x32_bf16 v[116:119], v[32:35], v[180:183], v[116:119]
    ds_read_b64_tr_b16 v[28:29], v8 offset:27680
    v_mfma_f32_16x16x32_bf16 v[152:155], v[32:35], v[184:187], v[152:155]
    ds_read_b64_tr_b16 v[30:31], v8 offset:32288
    s_waitcnt vmcnt(14)
    s_waitcnt lgkmcnt(6)
    v_mfma_f32_16x16x32_bf16 v[84:87], v[36:39], v[188:191], v[84:87]
    ds_read_b64_tr_b16 v[32:33], v10 offset:0
    v_mfma_f32_16x16x32_bf16 v[120:123], v[36:39], v[192:195], v[120:123]
    ds_read_b64_tr_b16 v[34:35], v10 offset:4608
    s_waitcnt lgkmcnt(6)
    v_mfma_f32_16x16x32_bf16 v[88:91], v[40:43], v[188:191], v[88:91]
    ds_read_b64_tr_b16 v[36:37], v10 offset:32
    v_mfma_f32_16x16x32_bf16 v[124:127], v[40:43], v[192:195], v[124:127]
    ds_read_b64_tr_b16 v[38:39], v10 offset:4640
    s_waitcnt vmcnt(12)
    s_waitcnt lgkmcnt(6)
    v_mfma_f32_16x16x32_bf16 v[84:87], v[44:47], v[196:199], v[84:87]
    ds_read_b64_tr_b16 v[40:41], v10 offset:9216
    v_mfma_f32_16x16x32_bf16 v[120:123], v[44:47], v[200:203], v[120:123]
    ds_read_b64_tr_b16 v[42:43], v10 offset:13824
    s_waitcnt lgkmcnt(6)
    v_mfma_f32_16x16x32_bf16 v[88:91], v[28:31], v[196:199], v[88:91]
    ds_read_b64_tr_b16 v[44:45], v10 offset:9248
    v_mfma_f32_16x16x32_bf16 v[124:127], v[28:31], v[200:203], v[124:127]
    ds_read_b64_tr_b16 v[46:47], v10 offset:13856
    s_waitcnt vmcnt(10)
    s_waitcnt lgkmcnt(6)
    v_mfma_f32_16x16x32_bf16 v[84:87], v[32:35], v[204:207], v[84:87]
    s_barrier
    ds_read_b64_tr_b16 v[28:29], v8 offset:0
    v_mfma_f32_16x16x32_bf16 v[120:123], v[32:35], v[208:211], v[120:123]
    ds_read_b64_tr_b16 v[30:31], v8 offset:4608
L_t7:
    s_cmp_eq_u32 s100, 1
    s_cbranch_scc1 L_wc
    s_waitcnt lgkmcnt(6)
    v_mfma_f32_16x16x32_bf16 v[88:91], v[36:39], v[204:207], v[88:91]
    ds_read_b64_tr_b16 v[32:33], v8 offset:32
    v_mfma_f32_16x16x32_bf16 v[124:127], v[36:39], v[208:211], v[124:127]
    ds_read_b64_tr_b16 v[34:35], v8 offset:4640
    s_waitcnt vmcnt(8)
    s_waitcnt lgkmcnt(6)
    v_mfma_f32_16x16x32_bf16 v[84:87], v[40:43], v[212:215], v[84:87]
    ds_read_b64_tr_b16 v[36:37], v8 offset:9216
    v_mfma_f32_16x16x32_bf16 v[120:123], v[40:43], v[216:219], v[120:123]
    ds_read_b64_tr_b16 v[38:39], v8 offset:13824
    s_waitcnt lgkmcnt(6)
    v_mfma_f32_16x16x32_bf16 v[88:91], v[44:47], v[212:215], v[88:91]
    ds_read_b64_tr_b16 v[40:41], v8 offset:9248
    v_mfma_f32_16x16x32_bf16 v[124:127], v[44:47], v[216:219], v[124:127]
    ds_read_b64_tr_b16 v[42:43], v8 offset:13856
    s_waitcnt vmcnt(6)
    s_waitcnt lgkmcnt(6)
    v_mfma_f32_16x16x32_bf16 v[84:87], v[28:31], v[220:223], v[84:87]
    ds_read_b64_tr_b16 v[44:45], v10 offset:18432
    v_mfma_f32_16x16x32_bf16 v[120:123], v[28:31], v[224:227], v[120:123]
    ds_read_b64_tr_b16 v[46:47], v10 offset:23040
    s_waitcnt lgkmcnt(6)
    v_mfma_f32_16x16x32_bf16 v[88:91], v[32:35], v[220:223], v[88:91]
    ds_read_b64_tr_b16 v[28:29], v10 offset:18464
    v_mfma_f32_16x16x32_bf16 v[124:127], v[32:35], v[224:227], v[124:127]
    ds_read_b64_tr_b16 v[30:31], v10 offset:23072
    s_waitcnt vmcnt(4)
    s_waitcnt lgkmcnt(6)
    v_mfma_f32_16x16x32_bf16 v[84:87], v[36:39], v[228:231], v[84:87]
    ds_read_b64_tr_b16 v[32:33], v10 offset:27648
    v_mfma_f32_16x16x32_bf16 v[120:123], v[36:39], v[232:235], v[120:123]
    ds_read_b64_tr_b16 v[34:35], v10 offset:32256
    s_waitcnt lgkmcnt(6)
    v_mfma_f32_16x16x32_bf16 v[88:91], v[40:43], v[228:231], v[88:91]
    ds_read_b64_tr_b16 v[36:37], v10 offset:27680
    v_mfma_f32_16x16x32_bf16 v[124:127], v[40:43], v[232:235], v[124:127]
    ds_read_b64_tr_b16 v[38:39], v10 offset:32288
    s_waitcnt vmcnt(2)
    s_waitcnt lgkmcnt(6)
    v_mfma_f32_16x16x32_bf16 v[84:87], v[44:47], v[236:239], v[84:87]
    ds_read_b64_tr_b16 v[40:41], v8 offset:18496
    v_mfma_f32_16x16x32_bf16 v[120:123], v[44:47], v[240:243], v[120:123]
    ds_read_b64_tr_b16 v[42:43], v8 offset:23104
    s_waitcnt lgkmcnt(6)
    v_mfma_f32_16x16x32_bf16 v[88:91], v[28:31], v[236:239], v[88:91]
    ds_read_b64_tr_b16 v[44:45], v8 offset:18528
    v_mfma_f32_16x16x32_bf16 v[124:127], v[28:31], v[240:243], v[124:127]
    ds_read_b64_tr_b16 v[46:47], v8 offset:23136
    s_waitcnt vmcnt(0)
    s_waitcnt lgkmcnt(6)
    v_mfma_f32_16x16x32_bf16 v[84:87], v[32:35], v[244:247], v[84:87]
    ds_read_b64_tr_b16 v[28:29], v8 offset:27712
    v_mfma_f32_16x16x32_bf16 v[120:123], v[32:35], v[248:251], v[120:123]
    ds_read_b64_tr_b16 v[30:31], v8 offset:32320
    s_waitcnt lgkmcnt(6)
    v_mfma_f32_16x16x32_bf16 v[88:91], v[36:39], v[244:247], v[88:91]
    ds_read_b64_tr_b16 v[32:33], v8 offset:27744
    v_mfma_f32_16x16x32_bf16 v[124:127], v[36:39], v[248:251], v[124:127]
    ds_read_b64_tr_b16 v[34:35], v8 offset:32352
    s_waitcnt lgkmcnt(6)
    v_mfma_f32_16x16x32_bf16 v[92:95], v[40:43], v[188:191], v[92:95]
    ds_read_b64_tr_b16 v[36:37], v10 offset:64
    v_mfma_f32_16x16x32_bf16 v[128:131], v[40:43], v[192:195], v[128:131]
    ds_read_b64_tr_b16 v[38:39], v10 offset:4672
    v_cvt_pk_bf16_f32 v52, v84, v85
    v_cvt_pk_bf16_f32 v53, v86, v87
    s_waitcnt lgkmcnt(6)
    v_mfma_f32_16x16x32_bf16 v[96:99], v[44:47], v[188:191], v[96:99]
    ds_read_b64_tr_b16 v[40:41], v10 offset:96
    v_cvt_pk_bf16_f32 v54, v88, v89
    v_cvt_pk_bf16_f32 v55, v90, v91
    v_mfma_f32_16x16x32_bf16 v[132:135], v[44:47], v[192:195], v[132:135]
    ds_read_b64_tr_b16 v[42:43], v10 offset:4704
    s_add_u32 s3, s30, 8388608
    buffer_store_dwordx4 v[52:55], v13, s[48:51], s3 offen sc1
    v_cvt_pk_bf16_f32 v56, v120, v121
    v_cvt_pk_bf16_f32 v57, v122, v123
    s_waitcnt lgkmcnt(6)
    v_mfma_f32_16x16x32_bf16 v[92:95], v[28:31], v[196:199], v[92:95]
    ds_read_b64_tr_b16 v[44:45], v10 offset:9280
    v_cvt_pk_bf16_f32 v58, v124, v125
    v_cvt_pk_bf16_f32 v59, v126, v127
    v_mfma_f32_16x16x32_bf16 v[128:131], v[28:31], v[200:203], v[128:131]
    ds_read_b64_tr_b16 v[46:47], v10 offset:13888
    s_add_u32 s3, s30, 8536064
    buffer_store_dwordx4 v[56:59], v13, s[48:51], s3 offen sc1
    s_waitcnt lgkmcnt(6)
    v_mfma_f32_16x16x32_bf16 v[96:99], v[32:35], v[196:199], v[96:99]
    ds_read_b64_tr_b16 v[28:29], v10 offset:9312
    v_mfma_f32_16x16x32_bf16 v[132:135], v[32:35], v[200:203], v[132:135]
    ds_read_b64_tr_b16 v[30:31], v10 offset:13920
    s_waitcnt lgkmcnt(6)
    v_mfma_f32_16x16x32_bf16 v[92:95], v[36:39], v[204:207], v[92:95]
    ds_read_b64_tr_b16 v[32:33], v8 offset:64
    v_mfma_f32_16x16x32_bf16 v[128:131], v[36:39], v[208:211], v[128:131]
    ds_read_b64_tr_b16 v[34:35], v8 offset:4672
    s_waitcnt lgkmcnt(6)
    v_mfma_f32_16x16x32_bf16 v[96:99], v[40:43], v[204:207], v[96:99]
    ds_read_b64_tr_b16 v[36:37], v8 offset:96
    v_mfma_f32_16x16x32_bf16 v[132:135], v[40:43], v[208:211], v[132:135]
    ds_read_b64_tr_b16 v[38:39], v8 offset:4704
    s_waitcnt lgkmcnt(6)
    v_mfma_f32_16x16x32_bf16 v[92:95], v[44:47], v[212:215], v[92:95]
    ds_read_b64_tr_b16 v[40:41], v8 offset:9280
    v_mfma_f32_16x16x32_bf16 v[128:131], v[44:47], v[216:219], v[128:131]
    ds_read_b64_tr_b16 v[42:43], v8 offset:13888
    s_waitcnt lgkmcnt(6)
    v_mfma_f32_16x16x32_bf16 v[96:99], v[28:31], v[212:215], v[96:99]
    ds_read_b64_tr_b16 v[44:45], v8 offset:9312
    v_mfma_f32_16x16x32_bf16 v[132:135], v[28:31], v[216:219], v[132:135]
    ds_read_b64_tr_b16 v[46:47], v8 offset:13920
    s_waitcnt lgkmcnt(6)
    v_mfma_f32_16x16x32_bf16 v[92:95], v[32:35], v[220:223], v[92:95]
    ds_read_b64_tr_b16 v[28:29], v10 offset:18496
    v_mfma_f32_16x16x32_bf16 v[128:131], v[32:35], v[224:227], v[128:131]
    ds_read_b64_tr_b16 v[30:31], v10 offset:23104
    s_waitcnt lgkmcnt(6)
    v_mfma_f32_16x16x32_bf16 v[96:99], v[36:39], v[220:223], v[96:99]
    ds_read_b64_tr_b16 v[32:33], v10 offset:18528
    v_mfma_f32_16x16x32_bf16 v[132:135], v[36:39], v[224:227], v[132:135]
    ds_read_b64_tr_b16 v[34:35], v10 offset:23136
    s_waitcnt lgkmcnt(6)
    v_mfma_f32_16x16x32_bf16 v[92:95], v[40:43], v[228:231], v[92:95]
    ds_read_b64_tr_b16 v[36:37], v10 offset:27712
    v_mfma_f32_16x16x32_bf16 v[128:131], v[40:43], v[232:235], v[128:131]
    ds_read_b64_tr_b16 v[38:39], v10 offset:32320
    s_waitcnt lgkmcnt(6)
    v_mfma_f32_16x16x32_bf16 v[96:99], v[44:47], v[228:231], v[96:99]
    ds_read_b64_tr_b16 v[40:41], v10 offset:27744
    v_mfma_f32_16x16x32_bf16 v[132:135], v[44:47], v[232:235], v[132:135]
    ds_read_b64_tr_b16 v[42:43], v10 offset:32352
    s_waitcnt lgkmcnt(6)
    v_mfma_f32_16x16x32_bf16 v[92:95], v[28:31], v[236:239], v[92:95]
    ds_read_b64_tr_b16 v[44:45], v8 offset:18560
    v_mfma_f32_16x16x32_bf16 v[128:131], v[28:31], v[240:243], v[128:131]
    ds_read_b64_tr_b16 v[46:47], v8 offset:23168
    s_waitcnt lgkmcnt(6)
    v_mfma_f32_16x16x32_bf16 v[96:99], v[32:35], v[236:239], v[96:99]
    ds_read_b64_tr_b16 v[28:29], v8 offset:18592
    v_mfma_f32_16x16x32_bf16 v[132:135], v[32:35], v[240:243], v[132:135]
    ds_read_b64_tr_b16 v[30:31], v8 offset:23200
    s_waitcnt lgkmcnt(6)
    v_mfma_f32_16x16x32_bf16 v[92:95], v[36:39], v[244:247], v[92:95]
    ds_read_b64_tr_b16 v[32:33], v8 offset:27776
    v_mfma_f32_16x16x32_bf16 v[128:131], v[36:39], v[248:251], v[128:131]
    ds_read_b64_tr_b16 v[34:35], v8 offset:32384
    s_waitcnt lgkmcnt(6)
    v_mfma_f32_16x16x32_bf16 v[96:99], v[40:43], v[244:247], v[96:99]
    ds_read_b64_tr_b16 v[36:37], v8 offset:27808
    v_mfma_f32_16x16x32_bf16 v[132:135], v[40:43], v[248:251], v[132:135]
    ds_read_b64_tr_b16 v[38:39], v8 offset:32416
    s_waitcnt lgkmcnt(6)
    v_mfma_f32_16x16x32_bf16 v[100:103], v[44:47], v[188:191], v[100:103]
    ds_read_b64_tr_b16 v[40:41], v10 offset:128
    v_mfma_f32_16x16x32_bf16 v[136:139], v[44:47], v[192:195], v[136:139]
    ds_read_b64_tr_b16 v[42:43], v10 offset:4736
    v_cvt_pk_bf16_f32 v60, v92, v93
    v_cvt_pk_bf16_f32 v61, v94, v95
    s_waitcnt lgkmcnt(6)
    v_mfma_f32_16x16x32_bf16 v[104:107], v[28:31], v[188:191], v[104:107]
    ds_read_b64_tr_b16 v[44:45], v10 offset:160
    v_cvt_pk_bf16_f32 v62, v96, v97
    v_cvt_pk_bf16_f32 v63, v98, v99
    v_mfma_f32_16x16x32_bf16 v[140:143], v[28:31], v[192:195], v[140:143]
    ds_read_b64_tr_b16 v[46:47], v10 offset:4768
    s_add_u32 s3, s30, 8389632
    buffer_store_dwordx4 v[60:63], v13, s[48:51], s3 offen sc1
    v_cvt_pk_bf16_f32 v64, v128, v129
    v_cvt_pk_bf16_f32 v65, v130, v131
    s_waitcnt lgkmcnt(6)
    v_mfma_f32_16x16x32_bf16 v[100:103], v[32:35], v[196:199], v[100:103]
    ds_read_b64_tr_b16 v[28:29], v10 offset:9344
    v_cvt_pk_bf16_f32 v66, v132, v133
    v_cvt_pk_bf16_f32 v67, v134, v135
    v_mfma_f32_16x16x32_bf16 v[136:139], v[32:35], v[200:203], v[136:139]
    ds_read_b64_tr_b16 v[30:31], v10 offset:13952
    s_add_u32 s3, s30, 8537088
    buffer_store_dwordx4 v[64:67], v13, s[48:51], s3 offen sc1
    s_waitcnt lgkmcnt(6)
    v_mfma_f32_16x16x32_bf16 v[104:107], v[36:39], v[196:199], v[104:107]
    ds_read_b64_tr_b16 v[32:33], v10 offset:9376
    v_mfma_f32_16x16x32_bf16 v[140:143], v[36:39], v[200:203], v[140:143]
    ds_read_b64_tr_b16 v[34:35], v10 offset:13984
    s_waitcnt lgkmcnt(6)
    v_mfma_f32_16x16x32_bf16 v[100:103], v[40:43], v[204:207], v[100:103]
    ds_read_b64_tr_b16 v[36:37], v8 offset:128
    v_mfma_f32_16x16x32_bf16 v[136:139], v[40:43], v[208:211], v[136:139]
    ds_read_b64_tr_b16 v[38:39], v8 offset:4736
    s_waitcnt lgkmcnt(6)
    v_mfma_f32_16x16x32_bf16 v[104:107], v[44:47], v[204:207], v[104:107]
    ds_read_b64_tr_b16 v[40:41], v8 offset:160
    v_mfma_f32_16x16x32_bf16 v[140:143], v[44:47], v[208:211], v[140:143]
    ds_read_b64_tr_b16 v[42:43], v8 offset:4768
    s_waitcnt lgkmcnt(6)
    v_mfma_f32_16x16x32_bf16 v[100:103], v[28:31], v[212:215], v[100:103]
    ds_read_b64_tr_b16 v[44:45], v8 offset:9344
    v_mfma_f32_16x16x32_bf16 v[136:139], v[28:31], v[216:219], v[136:139]
    ds_read_b64_tr_b16 v[46:47], v8 offset:13952
    s_waitcnt lgkmcnt(6)
    v_mfma_f32_16x16x32_bf16 v[104:107], v[32:35], v[212:215], v[104:107]
    ds_read_b64_tr_b16 v[28:29], v8 offset:9376
    v_mfma_f32_16x16x32_bf16 v[140:143], v[32:35], v[216:219], v[140:143]
    ds_read_b64_tr_b16 v[30:31], v8 offset:13984
    s_waitcnt lgkmcnt(6)
    v_mfma_f32_16x16x32_bf16 v[100:103], v[36:39], v[220:223], v[100:103]
    ds_read_b64_tr_b16 v[32:33], v10 offset:18560
    v_mfma_f32_16x16x32_bf16 v[136:139], v[36:39], v[224:227], v[136:139]
    ds_read_b64_tr_b16 v[34:35], v10 offset:23168
    s_waitcnt lgkmcnt(6)
    v_mfma_f32_16x16x32_bf16 v[104:107], v[40:43], v[220:223], v[104:107]
    ds_read_b64_tr_b16 v[36:37], v10 offset:18592
    v_mfma_f32_16x16x32_bf16 v[140:143], v[40:43], v[224:227], v[140:143]
    ds_read_b64_tr_b16 v[38:39], v10 offset:23200
    s_waitcnt lgkmcnt(6)
    v_mfma_f32_16x16x32_bf16 v[100:103], v[44:47], v[228:231], v[100:103]
    ds_read_b64_tr_b16 v[40:41], v10 offset:27776
    v_mfma_f32_16x16x32_bf16 v[136:139], v[44:47], v[232:235], v[136:139]
    ds_read_b64_tr_b16 v[42:43], v10 offset:32384
    s_waitcnt lgkmcnt(6)
    v_mfma_f32_16x16x32_bf16 v[104:107], v[28:31], v[228:231], v[104:107]
    ds_read_b64_tr_b16 v[44:45], v10 offset:27808
    v_mfma_f32_16x16x32_bf16 v[140:143], v[28:31], v[232:235], v[140:143]
    ds_read_b64_tr_b16 v[46:47], v10 offset:32416
    s_waitcnt lgkmcnt(6)
    v_mfma_f32_16x16x32_bf16 v[100:103], v[32:35], v[236:239], v[100:103]
    ds_read_b64_tr_b16 v[28:29], v8 offset:18624
    v_mfma_f32_16x16x32_bf16 v[136:139], v[32:35], v[240:243], v[136:139]
    ds_read_b64_tr_b16 v[30:31], v8 offset:23232
    s_waitcnt lgkmcnt(6)
    v_mfma_f32_16x16x32_bf16 v[104:107], v[36:39], v[236:239], v[104:107]
    ds_read_b64_tr_b16 v[32:33], v8 offset:18656
    v_mfma_f32_16x16x32_bf16 v[140:143], v[36:39], v[240:243], v[140:143]
    ds_read_b64_tr_b16 v[34:35], v8 offset:23264
    s_waitcnt lgkmcnt(6)
    v_mfma_f32_16x16x32_bf16 v[100:103], v[40:43], v[244:247], v[100:103]
    ds_read_b64_tr_b16 v[36:37], v8 offset:27840
    v_mfma_f32_16x16x32_bf16 v[136:139], v[40:43], v[248:251], v[136:139]
    ds_read_b64_tr_b16 v[38:39], v8 offset:32448
    s_waitcnt lgkmcnt(6)
    v_mfma_f32_16x16x32_bf16 v[104:107], v[44:47], v[244:247], v[104:107]
    ds_read_b64_tr_b16 v[40:41], v8 offset:27872
    v_mfma_f32_16x16x32_bf16 v[140:143], v[44:47], v[248:251], v[140:143]
    ds_read_b64_tr_b16 v[42:43], v8 offset:32480
    s_waitcnt lgkmcnt(6)
    v_mfma_f32_16x16x32_bf16 v[108:111], v[28:31], v[188:191], v[108:111]
    ds_read_b64_tr_b16 v[44:45], v10 offset:192
    v_mfma_f32_16x16x32_bf16 v[144:147], v[28:31], v[192:195], v[144:147]
    ds_read_b64_tr_b16 v[46:47], v10 offset:4800
    v_cvt_pk_bf16_f32 v68, v100, v101
    v_cvt_pk_bf16_f32 v69, v102, v103
    s_waitcnt lgkmcnt(6)
    v_mfma_f32_16x16x32_bf16 v[112:115], v[32:35], v[188:191], v[112:115]
    ds_read_b64_tr_b16 v[28:29], v10 offset:224
    v_cvt_pk_bf16_f32 v70, v104, v105
    v_cvt_pk_bf16_f32 v71, v106, v107
    v_mfma_f32_16x16x32_bf16 v[148:151], v[32:35], v[192:195], v[148:151]
    ds_read_b64_tr_b16 v[30:31], v10 offset:4832
    s_add_u32 s3, s30, 8390656
    buffer_store_dwordx4 v[68:71], v13, s[48:51], s3 offen sc1
    v_cvt_pk_bf16_f32 v72, v136, v137
    v_cvt_pk_bf16_f32 v73, v138, v139
    s_waitcnt lgkmcnt(6)
    v_mfma_f32_16x16x32_bf16 v[108:111], v[36:39], v[196:199], v[108:111]
    ds_read_b64_tr_b16 v[32:33], v10 offset:9408
    v_cvt_pk_bf16_f32 v74, v140, v141
    v_cvt_pk_bf16_f32 v75, v142, v143
    v_mfma_f32_16x16x32_bf16 v[144:147], v[36:39], v[200:203], v[144:147]
    ds_read_b64_tr_b16 v[34:35], v10 offset:14016
    s_add_u32 s3, s30, 8538112
    buffer_store_dwordx4 v[72:75], v13, s[48:51], s3 offen sc1
    s_waitcnt lgkmcnt(6)
    v_mfma_f32_16x16x32_bf16 v[112:115], v[40:43], v[196:199], v[112:115]
    ds_read_b64_tr_b16 v[36:37], v10 offset:9440
    v_mfma_f32_16x16x32_bf16 v[148:151], v[40:43], v[200:203], v[148:151]
    ds_read_b64_tr_b16 v[38:39], v10 offset:14048
    s_waitcnt lgkmcnt(6)
    v_mfma_f32_16x16x32_bf16 v[108:111], v[44:47], v[204:207], v[108:111]
    ds_read_b64_tr_b16 v[40:41], v8 offset:192
    v_mfma_f32_16x16x32_bf16 v[144:147], v[44:47], v[208:211], v[144:147]
    ds_read_b64_tr_b16 v[42:43], v8 offset:4800
    s_waitcnt lgkmcnt(6)
    v_mfma_f32_16x16x32_bf16 v[112:115], v[28:31], v[204:207], v[112:115]
    ds_read_b64_tr_b16 v[44:45], v8 offset:224
    v_mfma_f32_16x16x32_bf16 v[148:151], v[28:31], v[208:211], v[148:151]
    ds_read_b64_tr_b16 v[46:47], v8 offset:4832
    s_waitcnt lgkmcnt(6)
    v_mfma_f32_16x16x32_bf16 v[108:111], v[32:35], v[212:215], v[108:111]
    ds_read_b64_tr_b16 v[28:29], v8 offset:9408
    v_mfma_f32_16x16x32_bf16 v[144:147], v[32:35], v[216:219], v[144:147]
    ds_read_b64_tr_b16 v[30:31], v8 offset:14016
    s_waitcnt lgkmcnt(6)
    v_mfma_f32_16x16x32_bf16 v[112:115], v[36:39], v[212:215], v[112:115]
    ds_read_b64_tr_b16 v[32:33], v8 offset:9440
    v_mfma_f32_16x16x32_bf16 v[148:151], v[36:39], v[216:219], v[148:151]
    ds_read_b64_tr_b16 v[34:35], v8 offset:14048
    s_waitcnt lgkmcnt(6)
    v_mfma_f32_16x16x32_bf16 v[108:111], v[40:43], v[220:223], v[108:111]
    ds_read_b64_tr_b16 v[36:37], v10 offset:18624
    v_mfma_f32_16x16x32_bf16 v[144:147], v[40:43], v[224:227], v[144:147]
    ds_read_b64_tr_b16 v[38:39], v10 offset:23232
    s_waitcnt lgkmcnt(6)
    v_mfma_f32_16x16x32_bf16 v[112:115], v[44:47], v[220:223], v[112:115]
    ds_read_b64_tr_b16 v[40:41], v10 offset:18656
    v_mfma_f32_16x16x32_bf16 v[148:151], v[44:47], v[224:227], v[148:151]
    ds_read_b64_tr_b16 v[42:43], v10 offset:23264
    s_waitcnt lgkmcnt(6)
    v_mfma_f32_16x16x32_bf16 v[108:111], v[28:31], v[228:231], v[108:111]
    ds_read_b64_tr_b16 v[44:45], v10 offset:27840
    v_mfma_f32_16x16x32_bf16 v[144:147], v[28:31], v[232:235], v[144:147]
    ds_read_b64_tr_b16 v[46:47], v10 offset:32448
    s_waitcnt lgkmcnt(6)
    v_mfma_f32_16x16x32_bf16 v[112:115], v[32:35], v[228:231], v[112:115]
    ds_read_b64_tr_b16 v[28:29], v10 offset:27872
    v_mfma_f32_16x16x32_bf16 v[148:151], v[32:35], v[232:235], v[148:151]
    ds_read_b64_tr_b16 v[30:31], v10 offset:32480
    s_waitcnt lgkmcnt(6)
    v_mfma_f32_16x16x32_bf16 v[108:111], v[36:39], v[236:239], v[108:111]
    ds_read_b64_tr_b16 v[32:33], v8 offset:18688
    v_mfma_f32_16x16x32_bf16 v[144:147], v[36:39], v[240:243], v[144:147]
    ds_read_b64_tr_b16 v[34:35], v8 offset:23296
    s_waitcnt lgkmcnt(6)
    v_mfma_f32_16x16x32_bf16 v[112:115], v[40:43], v[236:239], v[112:115]
    ds_read_b64_tr_b16 v[36:37], v8 offset:27904
    s_waitcnt vmcnt(2)
    s_mov_b64 exec, 1
    buffer_store_dwordx2 v[252:253], off, s[48:51], s31 offset:0 sc1
    s_mov_b64 exec, -1
    v_mfma_f32_16x16x32_bf16 v[148:151], v[40:43], v[240:243], v[148:151]
    ds_read_b64_tr_b16 v[38:39], v8 offset:32512
    s_waitcnt lgkmcnt(6)
    v_mfma_f32_16x16x32_bf16 v[108:111], v[44:47], v[244:247], v[108:111]
    ds_read_b64_tr_b16 v[40:41], v10 offset:256
    v_mfma_f32_16x16x32_bf16 v[144:147], v[44:47], v[248:251], v[144:147]
    ds_read_b64_tr_b16 v[42:43], v10 offset:4864
    s_waitcnt lgkmcnt(6)
    v_mfma_f32_16x16x32_bf16 v[112:115], v[28:31], v[244:247], v[112:115]
    ds_read_b64_tr_b16 v[44:45], v10 offset:9472
    v_mfma_f32_16x16x32_bf16 v[148:151], v[28:31], v[248:251], v[148:151]
    ds_read_b64_tr_b16 v[46:47], v10 offset:14080
    s_waitcnt lgkmcnt(6)
    v_mfma_f32_16x16x32_bf16 v[116:119], v[32:35], v[188:191], v[116:119]
    ds_read_b64_tr_b16 v[28:29], v8 offset:256
    v_mfma_f32_16x16x32_bf16 v[152:155], v[32:35], v[192:195], v[152:155]
    ds_read_b64_tr_b16 v[30:31], v8 offset:4864
    v_cvt_pk_bf16_f32 v76, v108, v109
    v_cvt_pk_bf16_f32 v77, v110, v111
    s_waitcnt lgkmcnt(6)
    v_mfma_f32_16x16x32_bf16 v[116:119], v[36:39], v[196:199], v[116:119]
    ds_read_b64_tr_b16 v[32:33], v8 offset:9472
    v_cvt_pk_bf16_f32 v78, v112, v113
    v_cvt_pk_bf16_f32 v79, v114, v115
    v_mfma_f32_16x16x32_bf16 v[152:155], v[36:39], v[200:203], v[152:155]
    ds_read_b64_tr_b16 v[34:35], v8 offset:14080
    s_add_u32 s3, s30, 8391680
    buffer_store_dwordx4 v[76:79], v13, s[48:51], s3 offen sc1
    v_cvt_pk_bf16_f32 v80, v144, v145
    v_cvt_pk_bf16_f32 v81, v146, v147
    s_waitcnt lgkmcnt(6)
    v_mfma_f32_16x16x32_bf16 v[116:119], v[40:43], v[204:207], v[116:119]
    ds_read_b64_tr_b16 v[36:37], v10 offset:18688
    v_cvt_pk_bf16_f32 v82, v148, v149
    v_cvt_pk_bf16_f32 v83, v150, v151
    v_mfma_f32_16x16x32_bf16 v[152:155], v[40:43], v[208:211], v[152:155]
    ds_read_b64_tr_b16 v[38:39], v10 offset:23296
    s_add_u32 s3, s30, 8539136
    buffer_store_dwordx4 v[80:83], v13, s[48:51], s3 offen sc1
    s_waitcnt lgkmcnt(6)
    v_mfma_f32_16x16x32_bf16 v[116:119], v[44:47], v[212:215], v[116:119]
    ds_read_b64_tr_b16 v[40:41], v10 offset:27904
    v_mfma_f32_16x16x32_bf16 v[152:155], v[44:47], v[216:219], v[152:155]
    ds_read_b64_tr_b16 v[42:43], v10 offset:32512
    s_waitcnt lgkmcnt(6)
    v_mfma_f32_16x16x32_bf16 v[116:119], v[28:31], v[220:223], v[116:119]
    v_mfma_f32_16x16x32_bf16 v[152:155], v[28:31], v[224:227], v[152:155]
    s_waitcnt lgkmcnt(4)
    v_mfma_f32_16x16x32_bf16 v[116:119], v[32:35], v[228:231], v[116:119]
    v_mfma_f32_16x16x32_bf16 v[152:155], v[32:35], v[232:235], v[152:155]
    s_waitcnt lgkmcnt(2)
    v_mfma_f32_16x16x32_bf16 v[116:119], v[36:39], v[236:239], v[116:119]
    v_mfma_f32_16x16x32_bf16 v[152:155], v[36:39], v[240:243], v[152:155]
    s_waitcnt lgkmcnt(0)
    v_mfma_f32_16x16x32_bf16 v[116:119], v[40:43], v[244:247], v[116:119]
    v_mfma_f32_16x16x32_bf16 v[152:155], v[40:43], v[248:251], v[152:155]
    s_nop 6
    v_cvt_pk_bf16_f32 v52, v116, v117
    v_cvt_pk_bf16_f32 v53, v118, v119
    s_add_u32 s3, s30, 8392704
    buffer_store_dwordx2 v[52:53], v15, s[48:51], s3 offen sc1
    v_cvt_pk_bf16_f32 v56, v152, v153
    v_cvt_pk_bf16_f32 v57, v154, v155
    s_add_u32 s3, s30, 8540160
    buffer_store_dwordx2 v[56:57], v15, s[48:51], s3 offen sc1
    s_waitcnt vmcnt(5)
    s_mov_b64 exec, 1
    buffer_store_dwordx2 v[252:253], off, s[48:51], s31 offset:128 sc1
    s_mov_b64 exec, -1
    v_and_b32 v1, 7, v0
    v_lshlrev_b32 v1, 3, v1
    s_lshr_b32 s3, s27, 1
    s_lshl2_add_u32 s3, s3, s24
    s_lshl_b32 s3, s3, 10
    s_add_u32 s66, s3, 34603264
    s_lshl2_add_u32 s60, s27, s24
    s_mul_i32 s60, s60, 36864
    s_add_u32 s60, s60, 8388608
    v_lshlrev_b32 v5, 3, v0
    v_add_u32 v5, 4096, v5
    s_mul_i32 s62, s27, 18432
    s_mul_i32 s61, s24, 288
    s_add_u32 s62, s62, s61
    s_add_u32 s63, s62, 256
    v_and_b32 v6, 15, v0
    v_mul_u32_u24 v6, 1152, v6
    v_lshrrev_b32 v7, 4, v0
    v_lshl_add_u32 v6, v7, 3, v6
    s_mov_b32 s64, 0xffff0000
    s_mov_b32 s52, s14
    s_mov_b32 s53, s15
    s_mov_b32 s54, 1179648
    s_mov_b32 s55, 0x20000
    s_waitcnt vmcnt(1)
    s_mov_b64 exec, 1
    buffer_store_dwordx2 v[252:253], off, s[48:51], s31 offset:256 sc1
    s_mov_b64 exec, -1
    s_cmp_eq_u32 s20, 0
    s_cbranch_scc1 L_p3b
    s_endpgm
L_rt1:
    s_mov_b32 s3, 262144
L_rl1:
    buffer_load_dwordx2 v[2:3], v14, s[48:51], s28 offen sc1
    s_sub_u32 s3, s3, 1
    s_waitcnt vmcnt(0)
    s_cbranch_scc1 L_bk1
    v_cmp_eq_u64 vcc, v[2:3], v[252:253]
    s_lshr_b32 s94, vcc_lo, s24
    s_bitcmp1_b32 s94, 1
    s_cbranch_scc0 L_rl1
    s_branch L_bk1
L_rt2:
    s_mov_b32 s3, 262144
L_rl2:
    buffer_load_dwordx2 v[2:3], v14, s[48:51], s28 offen sc1
    s_sub_u32 s3, s3, 1
    s_waitcnt vmcnt(0)
    s_cbranch_scc1 L_bk2
    v_cmp_eq_u64 vcc, v[2:3], v[252:253]
    s_lshr_b32 s94, vcc_lo, s24
    s_bitcmp1_b32 s94, 2
    s_cbranch_scc0 L_rl2
    s_branch L_bk2
L_rt3:
    s_mov_b32 s3, 262144
L_rl3:
    buffer_load_dwordx2 v[2:3], v14, s[48:51], s28 offen sc1
    s_sub_u32 s3, s3, 1
    s_waitcnt vmcnt(0)
    s_cbranch_scc1 L_bk3
    v_cmp_eq_u64 vcc, v[2:3], v[252:253]
    s_lshr_b32 s94, vcc_lo, s24
    s_bitcmp1_b32 s94, 3
    s_cbranch_scc0 L_rl3
    s_branch L_bk3
L_far:
    buffer_store_dwordx4 v[52:55], v12, s[48:51], s64 offen offset:0 sc1
    buffer_store_dwordx4 v[56:59], v12, s[48:51], s64 offen offset:1024 sc1
    buffer_store_dwordx4 v[60:63], v12, s[48:51], s64 offen offset:2048 sc1
    buffer_store_dwordx4 v[64:67], v12, s[48:51], s64 offen offset:3072 sc1
    buffer_store_dwordx4 v[68:71], v12, s[48:51], s65 offen offset:0 sc1
    buffer_store_dwordx4 v[72:75], v12, s[48:51], s65 offen offset:1024 sc1
    buffer_store_dwordx4 v[76:79], v12, s[48:51], s65 offen offset:2048 sc1
    buffer_store_dwordx4 v[80:83], v12, s[48:51], s65 offen offset:3072 sc1
    s_waitcnt vmcnt(0)
    s_mov_b64 exec, 1
    buffer_store_dwordx2 v[252:253], off, s[48:51], s29 sc1
    s_branch L_near
L_nonzc:
    s_mov_b32 s3, 262144
L_nonpc:
    buffer_load_dwordx2 v[2:3], off, s[56:59], s92 sc1
    s_sub_u32 s3, s3, 1
    s_waitcnt vmcnt(0)
    s_cbranch_scc1 L_nonc
    v_readfirstlane_b32 s96, v2
    v_readfirstlane_b32 s97, v3
    s_cmp_eq_u32 s96, 0
    s_cbranch_scc1 L_nonpc
    s_branch L_nonc
L_nonzl:
    s_mov_b32 s3, 262144
L_nonpl:
    buffer_load_dwordx2 v[2:3], off, s[56:59], s92 sc1
    s_sub_u32 s3, s3, 1
    s_waitcnt vmcnt(0)
    s_cbranch_scc1 L_nonl
    v_readfirstlane_b32 s96, v2
    v_readfirstlane_b32 s97, v3
    s_cmp_eq_u32 s96, 0
    s_cbranch_scc1 L_nonpl
    s_branch L_nonl
L_slow:
    s_waitcnt lgkmcnt(0)
    s_nop 15
    v_and_b32 v1, 31, v0
    v_lshrrev_b32 v2, 5, v0
    v_lshlrev_b32 v3, 8, v1
    v_lshl_add_u32 v3, v2, 4, v3
    v_and_b32 v4, 19, v1
    v_bfe_u32 v5, v1, 2, 1
    v_lshl_add_u32 v4, v5, 3, v4
    v_bfe_u32 v5, v1, 3, 1
    v_lshl_add_u32 v4, v5, 2, v4
    v_lshlrev_b32 v4, 1, v4
    v_lshl_add_u32 v4, v2, 10, v4
    v_mov_b32 v26, 0xff800000
    s_mov_b32 s68, 0
L_s1:

    buffer_load_dwordx4 v[212:215], v3, s[36:39], s68 offen offset:0
    buffer_load_dwordx4 v[216:219], v3, s[36:39], s68 offen offset:32
    buffer_load_dwordx4 v[220:223], v3, s[36:39], s68 offen offset:64
    buffer_load_dwordx4 v[224:227], v3, s[36:39], s68 offen offset:96
    buffer_load_dwordx4 v[228:231], v3, s[36:39], s68 offen offset:128
    buffer_load_dwordx4 v[232:235], v3, s[36:39], s68 offen offset:160
    buffer_load_dwordx4 v[236:239], v3, s[36:39], s68 offen offset:192
    buffer_load_dwordx4 v[240:243], v3, s[36:39], s68 offen offset:224
    s_waitcnt vmcnt(0)
    v_mfma_f32_32x32x16_bf16 v[100:115], v[212:215], v[52:55], 0
    v_mfma_f32_32x32x16_bf16 v[100:115], v[216:219], v[56:59], v[100:115]
    v_mfma_f32_32x32x16_bf16 v[100:115], v[220:223], v[60:63], v[100:115]
    v_mfma_f32_32x32x16_bf16 v[100:115], v[224:227], v[64:67], v[100:115]
    v_mfma_f32_32x32x16_bf16 v[100:115], v[228:231], v[68:71], v[100:115]
    v_mfma_f32_32x32x16_bf16 v[100:115], v[232:235], v[72:75], v[100:115]
    v_mfma_f32_32x32x16_bf16 v[100:115], v[236:239], v[76:79], v[100:115]
    v_mfma_f32_32x32x16_bf16 v[100:115], v[240:243], v[80:83], v[100:115]
    s_nop 11
    v_max3_f32 v26, v26, v100, v101
    v_max_f32 v26, v26, v102
    v_max3_f32 v26, v26, v103, v104
    v_max3_f32 v26, v26, v105, v106
    v_max3_f32 v26, v26, v107, v108
    v_max3_f32 v26, v26, v109, v110
    v_max3_f32 v26, v26, v111, v112
    v_max3_f32 v26, v26, v113, v114
    v_max_f32 v26, v26, v115
    s_add_u32 s68, s68, 8192
    s_cmp_lt_u32 s68, 131072
    s_cbranch_scc1 L_s1
    v_mov_b32 v27, v26
    s_nop 1
    v_permlane32_swap_b32 v26, v27
    v_max_f32 v26, v26, v27
    v_sub_f32 v84, 0, v26
    v_sub_f32 v85, 0, v26
    v_mov_b32 v86, v84
    v_mov_b32 v87, v84
    v_mov_b32 v88, v84
    v_mov_b32 v89, v84
    v_mov_b32 v90, v84
    v_mov_b32 v91, v84
    v_mov_b32 v92, v84
    v_mov_b32 v93, v84
    v_mov_b32 v94, v84
    v_mov_b32 v95, v84
    v_mov_b32 v96, v84
    v_mov_b32 v97, v84
    v_mov_b32 v98, v84
    v_mov_b32 v99, v84
    v_mov_b32 v148, 0
    v_mov_b32 v149, 0
    v_mov_b32 v150, 0
    v_mov_b32 v151, 0
    v_mov_b32 v152, 0
    v_mov_b32 v153, 0
    v_mov_b32 v154, 0
    v_mov_b32 v155, 0
    v_mov_b32 v156, 0
    v_mov_b32 v157, 0
    v_mov_b32 v158, 0
    v_mov_b32 v159, 0
    v_mov_b32 v160, 0
    v_mov_b32 v161, 0
    v_mov_b32 v162, 0
    v_mov_b32 v163, 0
    v_mov_b32 v164, 0
    v_mov_b32 v165, 0
    v_mov_b32 v166, 0
    v_mov_b32 v167, 0
    v_mov_b32 v168, 0
    v_mov_b32 v169, 0
    v_mov_b32 v170, 0
    v_mov_b32 v171, 0
    v_mov_b32 v172, 0
    v_mov_b32 v173, 0
    v_mov_b32 v174, 0
    v_mov_b32 v175, 0
    v_mov_b32 v176, 0
    v_mov_b32 v177, 0
    v_mov_b32 v178, 0
    v_mov_b32 v179, 0
    v_mov_b32 v180, 0
    v_mov_b32 v181, 0
    v_mov_b32 v182, 0
    v_mov_b32 v183, 0
    v_mov_b32 v184, 0
    v_mov_b32 v185, 0
    v_mov_b32 v186, 0
    v_mov_b32 v187, 0
    v_mov_b32 v188, 0
    v_mov_b32 v189, 0
    v_mov_b32 v190, 0
    v_mov_b32 v191, 0
    v_mov_b32 v192, 0
    v_mov_b32 v193, 0
    v_mov_b32 v194, 0
    v_mov_b32 v195, 0
    v_mov_b32 v196, 0
    v_mov_b32 v197, 0
    v_mov_b32 v198, 0
    v_mov_b32 v199, 0
    v_mov_b32 v200, 0
    v_mov_b32 v201, 0
    v_mov_b32 v202, 0
    v_mov_b32 v203, 0
    v_mov_b32 v204, 0
    v_mov_b32 v205, 0
    v_mov_b32 v206, 0
    v_mov_b32 v207, 0
    v_mov_b32 v208, 0
    v_mov_b32 v209, 0
    v_mov_b32 v210, 0
    v_mov_b32 v211, 0
    v_mov_b32 v24, 0
    v_mov_b32 v25, 0
    s_mov_b32 s68, 0
L_s2:
    buffer_load_dwordx4 v[212:215], v3, s[36:39], s68 offen offset:0
    buffer_load_dwordx4 v[216:219], v3, s[36:39], s68 offen offset:32
    buffer_load_dwordx4 v[220:223], v3, s[36:39], s68 offen offset:64
    buffer_load_dwordx4 v[224:227], v3, s[36:39], s68 offen offset:96
    buffer_load_dwordx4 v[228:231], v3, s[36:39], s68 offen offset:128
    buffer_load_dwordx4 v[232:235], v3, s[36:39], s68 offen offset:160
    buffer_load_dwordx4 v[236:239], v3, s[36:39], s68 offen offset:192
    buffer_load_dwordx4 v[240:243], v3, s[36:39], s68 offen offset:224
    s_waitcnt vmcnt(0)
    v_mfma_f32_32x32x16_bf16 v[100:115], v[212:215], v[52:55], v[84:99]
    v_mfma_f32_32x32x16_bf16 v[100:115], v[216:219], v[56:59], v[100:115]
    v_mfma_f32_32x32x16_bf16 v[100:115], v[220:223], v[60:63], v[100:115]
    v_mfma_f32_32x32x16_bf16 v[100:115], v[224:227], v[64:67], v[100:115]
    v_mfma_f32_32x32x16_bf16 v[100:115], v[228:231], v[68:71], v[100:115]
    v_mfma_f32_32x32x16_bf16 v[100:115], v[232:235], v[72:75], v[100:115]
    v_mfma_f32_32x32x16_bf16 v[100:115], v[236:239], v[76:79], v[100:115]
    v_mfma_f32_32x32x16_bf16 v[100:115], v[240:243], v[80:83], v[100:115]
    s_nop 11
    v_exp_f32 v100, v100
    v_exp_f32 v101, v101
    v_exp_f32 v102, v102
    v_exp_f32 v103, v103
    v_exp_f32 v104, v104
    v_exp_f32 v105, v105
    v_exp_f32 v106, v106
    v_exp_f32 v107, v107
    v_exp_f32 v108, v108
    v_exp_f32 v109, v109
    v_exp_f32 v110, v110
    v_exp_f32 v111, v111
    v_exp_f32 v112, v112
    v_exp_f32 v113, v113
    v_exp_f32 v26, v114
    v_exp_f32 v27, v115
    v_cvt_pk_bf16_f32 v132, v100, v101
    v_add_f32 v24, v24, v100
    v_add_f32 v25, v25, v101
    v_cvt_pk_bf16_f32 v133, v102, v103
    v_add_f32 v24, v24, v102
    v_add_f32 v25, v25, v103
    v_cvt_pk_bf16_f32 v134, v104, v105
    v_add_f32 v24, v24, v104
    v_add_f32 v25, v25, v105
    v_cvt_pk_bf16_f32 v135, v106, v107
    v_add_f32 v24, v24, v106
    v_add_f32 v25, v25, v107
    v_cvt_pk_bf16_f32 v136, v108, v109
    v_add_f32 v24, v24, v108
    v_add_f32 v25, v25, v109
    v_cvt_pk_bf16_f32 v137, v110, v111
    v_add_f32 v24, v24, v110
    v_add_f32 v25, v25, v111
    v_cvt_pk_bf16_f32 v138, v112, v113
    v_add_f32 v24, v24, v112
    v_add_f32 v25, v25, v113
    v_cvt_pk_bf16_f32 v139, v26, v27
    v_add_f32 v24, v24, v26
    v_add_f32 v25, v25, v27
    s_add_u32 s69, s68, 4096
    buffer_load_ushort v212, v4, s[40:43], s68 offen offset:0
    buffer_load_ushort v213, v4, s[40:43], s68 offen offset:256
    buffer_load_ushort v214, v4, s[40:43], s68 offen offset:512
    buffer_load_ushort v215, v4, s[40:43], s68 offen offset:768
    buffer_load_ushort v216, v4, s[40:43], s68 offen offset:2048
    buffer_load_ushort v217, v4, s[40:43], s68 offen offset:2304
    buffer_load_ushort v218, v4, s[40:43], s68 offen offset:2560
    buffer_load_ushort v219, v4, s[40:43], s68 offen offset:2816
    s_waitcnt vmcnt(0)
    v_lshl_or_b32 v220, v213, 16, v212
    v_lshl_or_b32 v221, v215, 16, v214
    v_lshl_or_b32 v222, v217, 16, v216
    v_lshl_or_b32 v223, v219, 16, v218
    s_nop 1
    v_mfma_f32_32x32x16_bf16 v[148:163], v[220:223], v[132:135], v[148:163]
    buffer_load_ushort v212, v4, s[40:43], s69 offen offset:0
    buffer_load_ushort v213, v4, s[40:43], s69 offen offset:256
    buffer_load_ushort v214, v4, s[40:43], s69 offen offset:512
    buffer_load_ushort v215, v4, s[40:43], s69 offen offset:768
    buffer_load_ushort v216, v4, s[40:43], s69 offen offset:2048
    buffer_load_ushort v217, v4, s[40:43], s69 offen offset:2304
    buffer_load_ushort v218, v4, s[40:43], s69 offen offset:2560
    buffer_load_ushort v219, v4, s[40:43], s69 offen offset:2816
    s_waitcnt vmcnt(0)
    v_lshl_or_b32 v220, v213, 16, v212
    v_lshl_or_b32 v221, v215, 16, v214
    v_lshl_or_b32 v222, v217, 16, v216
    v_lshl_or_b32 v223, v219, 16, v218
    s_nop 1
    v_mfma_f32_32x32x16_bf16 v[148:163], v[220:223], v[136:139], v[148:163]
    buffer_load_ushort v212, v4, s[40:43], s68 offen offset:64
    buffer_load_ushort v213, v4, s[40:43], s68 offen offset:320
    buffer_load_ushort v214, v4, s[40:43], s68 offen offset:576
    buffer_load_ushort v215, v4, s[40:43], s68 offen offset:832
    buffer_load_ushort v216, v4, s[40:43], s68 offen offset:2112
    buffer_load_ushort v217, v4, s[40:43], s68 offen offset:2368
    buffer_load_ushort v218, v4, s[40:43], s68 offen offset:2624
    buffer_load_ushort v219, v4, s[40:43], s68 offen offset:2880
    s_waitcnt vmcnt(0)
    v_lshl_or_b32 v220, v213, 16, v212
    v_lshl_or_b32 v221, v215, 16, v214
    v_lshl_or_b32 v222, v217, 16, v216
    v_lshl_or_b32 v223, v219, 16, v218
    s_nop 1
    v_mfma_f32_32x32x16_bf16 v[164:179], v[220:223], v[132:135], v[164:179]
    buffer_load_ushort v212, v4, s[40:43], s69 offen offset:64
    buffer_load_ushort v213, v4, s[40:43], s69 offen offset:320
    buffer_load_ushort v214, v4, s[40:43], s69 offen offset:576
    buffer_load_ushort v215, v4, s[40:43], s69 offen offset:832
    buffer_load_ushort v216, v4, s[40:43], s69 offen offset:2112
    buffer_load_ushort v217, v4, s[40:43], s69 offen offset:2368
    buffer_load_ushort v218, v4, s[40:43], s69 offen offset:2624
    buffer_load_ushort v219, v4, s[40:43], s69 offen offset:2880
    s_waitcnt vmcnt(0)
    v_lshl_or_b32 v220, v213, 16, v212
    v_lshl_or_b32 v221, v215, 16, v214
    v_lshl_or_b32 v222, v217, 16, v216
    v_lshl_or_b32 v223, v219, 16, v218
    s_nop 1
    v_mfma_f32_32x32x16_bf16 v[164:179], v[220:223], v[136:139], v[164:179]
    buffer_load_ushort v212, v4, s[40:43], s68 offen offset:128
    buffer_load_ushort v213, v4, s[40:43], s68 offen offset:384
    buffer_load_ushort v214, v4, s[40:43], s68 offen offset:640
    buffer_load_ushort v215, v4, s[40:43], s68 offen offset:896
    buffer_load_ushort v216, v4, s[40:43], s68 offen offset:2176
    buffer_load_ushort v217, v4, s[40:43], s68 offen offset:2432
    buffer_load_ushort v218, v4, s[40:43], s68 offen offset:2688
    buffer_load_ushort v219, v4, s[40:43], s68 offen offset:2944
    s_waitcnt vmcnt(0)
    v_lshl_or_b32 v220, v213, 16, v212
    v_lshl_or_b32 v221, v215, 16, v214
    v_lshl_or_b32 v222, v217, 16, v216
    v_lshl_or_b32 v223, v219, 16, v218
    s_nop 1
    v_mfma_f32_32x32x16_bf16 v[180:195], v[220:223], v[132:135], v[180:195]
    buffer_load_ushort v212, v4, s[40:43], s69 offen offset:128
    buffer_load_ushort v213, v4, s[40:43], s69 offen offset:384
    buffer_load_ushort v214, v4, s[40:43], s69 offen offset:640
    buffer_load_ushort v215, v4, s[40:43], s69 offen offset:896
    buffer_load_ushort v216, v4, s[40:43], s69 offen offset:2176
    buffer_load_ushort v217, v4, s[40:43], s69 offen offset:2432
    buffer_load_ushort v218, v4, s[40:43], s69 offen offset:2688
    buffer_load_ushort v219, v4, s[40:43], s69 offen offset:2944
    s_waitcnt vmcnt(0)
    v_lshl_or_b32 v220, v213, 16, v212
    v_lshl_or_b32 v221, v215, 16, v214
    v_lshl_or_b32 v222, v217, 16, v216
    v_lshl_or_b32 v223, v219, 16, v218
    s_nop 1
    v_mfma_f32_32x32x16_bf16 v[180:195], v[220:223], v[136:139], v[180:195]
    buffer_load_ushort v212, v4, s[40:43], s68 offen offset:192
    buffer_load_ushort v213, v4, s[40:43], s68 offen offset:448
    buffer_load_ushort v214, v4, s[40:43], s68 offen offset:704
    buffer_load_ushort v215, v4, s[40:43], s68 offen offset:960
    buffer_load_ushort v216, v4, s[40:43], s68 offen offset:2240
    buffer_load_ushort v217, v4, s[40:43], s68 offen offset:2496
    buffer_load_ushort v218, v4, s[40:43], s68 offen offset:2752
    buffer_load_ushort v219, v4, s[40:43], s68 offen offset:3008
    s_waitcnt vmcnt(0)
    v_lshl_or_b32 v220, v213, 16, v212
    v_lshl_or_b32 v221, v215, 16, v214
    v_lshl_or_b32 v222, v217, 16, v216
    v_lshl_or_b32 v223, v219, 16, v218
    s_nop 1
    v_mfma_f32_32x32x16_bf16 v[196:211], v[220:223], v[132:135], v[196:211]
    buffer_load_ushort v212, v4, s[40:43], s69 offen offset:192
    buffer_load_ushort v213, v4, s[40:43], s69 offen offset:448
    buffer_load_ushort v214, v4, s[40:43], s69 offen offset:704
    buffer_load_ushort v215, v4, s[40:43], s69 offen offset:960
    buffer_load_ushort v216, v4, s[40:43], s69 offen offset:2240
    buffer_load_ushort v217, v4, s[40:43], s69 offen offset:2496
    buffer_load_ushort v218, v4, s[40:43], s69 offen offset:2752
    buffer_load_ushort v219, v4, s[40:43], s69 offen offset:3008
    s_waitcnt vmcnt(0)
    v_lshl_or_b32 v220, v213, 16, v212
    v_lshl_or_b32 v221, v215, 16, v214
    v_lshl_or_b32 v222, v217, 16, v216
    v_lshl_or_b32 v223, v219, 16, v218
    s_nop 1
    v_mfma_f32_32x32x16_bf16 v[196:211], v[220:223], v[136:139], v[196:211]
    s_add_u32 s68, s68, 8192
    s_cmp_lt_u32 s68, 131072
    s_cbranch_scc1 L_s2
    v_add_f32 v24, v24, v25
    v_mov_b32 v25, v24
    s_nop 1
    v_permlane32_swap_b32 v24, v25
    v_add_f32 v24, v24, v25
    v_rcp_f32 v24, v24
    v_lshlrev_b32 v12, 4, v0
    s_lshl_b32 s3, s25, 13
    v_add_u32 v12, s3, v12
    s_lshl2_add_u32 s3, s27, s24
    s_lshl_b32 s64, s3, 15
    s_add_u32 s65, s64, 4096
    v_lshrrev_b32 v1, 2, v0
    v_mul_u32_u24 v1, 288, v1
    v_and_b32 v2, 3, v0
    v_lshl_add_u32 v8, v2, 3, v1
    v_add_u32 v9, 55296, v8
    v_add_u32 v10, 110592, v8
    v_lshlrev_b32 v14, 3, v2
    s_nop 7
    v_pk_mul_f32 v[148:149], v[148:149], v[24:25] op_sel_hi:[1,0]
    v_pk_mul_f32 v[150:151], v[150:151], v[24:25] op_sel_hi:[1,0]
    v_pk_mul_f32 v[152:153], v[152:153], v[24:25] op_sel_hi:[1,0]
    v_pk_mul_f32 v[154:155], v[154:155], v[24:25] op_sel_hi:[1,0]
    v_cvt_pk_bf16_f32 v52, v148, v149
    v_cvt_pk_bf16_f32 v53, v150, v151
    v_cvt_pk_bf16_f32 v54, v152, v153
    v_cvt_pk_bf16_f32 v55, v154, v155
    v_pk_mul_f32 v[156:157], v[156:157], v[24:25] op_sel_hi:[1,0]
    v_pk_mul_f32 v[158:159], v[158:159], v[24:25] op_sel_hi:[1,0]
    v_pk_mul_f32 v[160:161], v[160:161], v[24:25] op_sel_hi:[1,0]
    v_pk_mul_f32 v[162:163], v[162:163], v[24:25] op_sel_hi:[1,0]
    v_cvt_pk_bf16_f32 v56, v156, v157
    v_cvt_pk_bf16_f32 v57, v158, v159
    v_cvt_pk_bf16_f32 v58, v160, v161
    v_cvt_pk_bf16_f32 v59, v162, v163
    v_permlane16_swap_b32 v52, v56
    v_permlane16_swap_b32 v53, v57
    v_permlane16_swap_b32 v54, v58
    v_permlane16_swap_b32 v55, v59
    buffer_store_dwordx4 v[52:55], v12, s[48:51], s64 offen offset:0
    buffer_store_dwordx4 v[56:59], v12, s[48:51], s64 offen offset:1024
    v_pk_mul_f32 v[164:165], v[164:165], v[24:25] op_sel_hi:[1,0]
    v_pk_mul_f32 v[166:167], v[166:167], v[24:25] op_sel_hi:[1,0]
    v_pk_mul_f32 v[168:169], v[168:169], v[24:25] op_sel_hi:[1,0]
    v_pk_mul_f32 v[170:171], v[170:171], v[24:25] op_sel_hi:[1,0]
    v_cvt_pk_bf16_f32 v60, v164, v165
    v_cvt_pk_bf16_f32 v61, v166, v167
    v_cvt_pk_bf16_f32 v62, v168, v169
    v_cvt_pk_bf16_f32 v63, v170, v171
    v_pk_mul_f32 v[172:173], v[172:173], v[24:25] op_sel_hi:[1,0]
    v_pk_mul_f32 v[174:175], v[174:175], v[24:25] op_sel_hi:[1,0]
    v_pk_mul_f32 v[176:177], v[176:177], v[24:25] op_sel_hi:[1,0]
    v_pk_mul_f32 v[178:179], v[178:179], v[24:25] op_sel_hi:[1,0]
    v_cvt_pk_bf16_f32 v64, v172, v173
    v_cvt_pk_bf16_f32 v65, v174, v175
    v_cvt_pk_bf16_f32 v66, v176, v177
    v_cvt_pk_bf16_f32 v67, v178, v179
    v_permlane16_swap_b32 v60, v64
    v_permlane16_swap_b32 v61, v65
    v_permlane16_swap_b32 v62, v66
    v_permlane16_swap_b32 v63, v67
    buffer_store_dwordx4 v[60:63], v12, s[48:51], s64 offen offset:2048
    buffer_store_dwordx4 v[64:67], v12, s[48:51], s64 offen offset:3072
    v_pk_mul_f32 v[180:181], v[180:181], v[24:25] op_sel_hi:[1,0]
    v_pk_mul_f32 v[182:183], v[182:183], v[24:25] op_sel_hi:[1,0]
    v_pk_mul_f32 v[184:185], v[184:185], v[24:25] op_sel_hi:[1,0]
    v_pk_mul_f32 v[186:187], v[186:187], v[24:25] op_sel_hi:[1,0]
    v_cvt_pk_bf16_f32 v68, v180, v181
    v_cvt_pk_bf16_f32 v69, v182, v183
    v_cvt_pk_bf16_f32 v70, v184, v185
    v_cvt_pk_bf16_f32 v71, v186, v187
    v_pk_mul_f32 v[188:189], v[188:189], v[24:25] op_sel_hi:[1,0]
    v_pk_mul_f32 v[190:191], v[190:191], v[24:25] op_sel_hi:[1,0]
    v_pk_mul_f32 v[192:193], v[192:193], v[24:25] op_sel_hi:[1,0]
    v_pk_mul_f32 v[194:195], v[194:195], v[24:25] op_sel_hi:[1,0]
    v_cvt_pk_bf16_f32 v72, v188, v189
    v_cvt_pk_bf16_f32 v73, v190, v191
    v_cvt_pk_bf16_f32 v74, v192, v193
    v_cvt_pk_bf16_f32 v75, v194, v195
    v_permlane16_swap_b32 v68, v72
    v_permlane16_swap_b32 v69, v73
    v_permlane16_swap_b32 v70, v74
    v_permlane16_swap_b32 v71, v75
    buffer_store_dwordx4 v[68:71], v12, s[48:51], s65 offen offset:0
    buffer_store_dwordx4 v[72:75], v12, s[48:51], s65 offen offset:1024
    v_pk_mul_f32 v[196:197], v[196:197], v[24:25] op_sel_hi:[1,0]
    v_pk_mul_f32 v[198:199], v[198:199], v[24:25] op_sel_hi:[1,0]
    v_pk_mul_f32 v[200:201], v[200:201], v[24:25] op_sel_hi:[1,0]
    v_pk_mul_f32 v[202:203], v[202:203], v[24:25] op_sel_hi:[1,0]
    v_cvt_pk_bf16_f32 v76, v196, v197
    v_cvt_pk_bf16_f32 v77, v198, v199
    v_cvt_pk_bf16_f32 v78, v200, v201
    v_cvt_pk_bf16_f32 v79, v202, v203
    v_pk_mul_f32 v[204:205], v[204:205], v[24:25] op_sel_hi:[1,0]
    v_pk_mul_f32 v[206:207], v[206:207], v[24:25] op_sel_hi:[1,0]
    v_pk_mul_f32 v[208:209], v[208:209], v[24:25] op_sel_hi:[1,0]
    v_pk_mul_f32 v[210:211], v[210:211], v[24:25] op_sel_hi:[1,0]
    v_cvt_pk_bf16_f32 v80, v204, v205
    v_cvt_pk_bf16_f32 v81, v206, v207
    v_cvt_pk_bf16_f32 v82, v208, v209
    v_cvt_pk_bf16_f32 v83, v210, v211
    v_permlane16_swap_b32 v76, v80
    v_permlane16_swap_b32 v77, v81
    v_permlane16_swap_b32 v78, v82
    v_permlane16_swap_b32 v79, v83
    buffer_store_dwordx4 v[76:79], v12, s[48:51], s65 offen offset:2048
    buffer_store_dwordx4 v[80:83], v12, s[48:51], s65 offen offset:3072
    s_nop 3
    s_branch L_p2
.section .rodata,"a"
.p2align 6
.amdhsa_kernel standalone__gqa_block_cached__near_ridge_kernel
  .amdhsa_next_free_vgpr 256
  .amdhsa_next_free_sgpr 102
  .amdhsa_accum_offset 256
  .amdhsa_group_segment_fixed_size 0
  .amdhsa_kernarg_size 64
  .amdhsa_user_sgpr_count 2
  .amdhsa_user_sgpr_kernarg_segment_ptr 1
  .amdhsa_system_sgpr_workgroup_id_x 1
.end_amdhsa_kernel
```
